```python
import torch

def _softmax(x, axis=-1):
    return torch.softmax(x, dim=axis)
def _gelu(x):
    return torch.nn.functional.gelu(x, approximate="tanh")
def _silu(x):
    return torch.nn.functional.silu(x)
def _sigmoid(x):
    return torch.sigmoid(x)
def _layernorm(x, axis=-1, eps=1e-5):
    m = x.mean(dim=axis, keepdim=True)
    v = x.var(dim=axis, keepdim=True, unbiased=False)
    return (x - m) / torch.sqrt(v + eps)
def _scatter_add(tgt, idx, src, axis=0):
    return tgt.clone().index_add_(axis, idx, src)
def _segment_sum(src, seg, n):
    out = torch.zeros((n,) + src.shape[1:], dtype=src.dtype)
    return out.index_add_(0, seg, src)
def _pad(x, pw):
    flat = tuple(v for pair in reversed(pw) for v in pair)
    return torch.nn.functional.pad(x, flat)

kernel_name = 'standalone__sliding_window_attn__prompt'

def setup_inputs():

    _w = (lambda a: (lambda t: t.to(torch.bfloat16) if t.is_floating_point() else t)(torch.as_tensor(a)))
    B, H, S, D = 1, 32, 2048, 192
    return {
        "q": _w((lambda *s: torch.randn(*s, dtype=torch.bfloat16) * 0.8)(B, H, S, D)),
        "k": _w((lambda *s: torch.randn(*s, dtype=torch.bfloat16) * 0.8)(B, H, S, D)),
        "v": _w((lambda *s: torch.randn(*s, dtype=torch.bfloat16) * 0.05)(B, H, S, D)),
        "window": 256,
    }

def reference(q, k, v, window):
    B, H, S, D = q.shape
    scale = D ** -0.5
    scores = torch.einsum("bhqd,bhkd->bhqk", q, k) * scale
    idx = torch.arange(S)
    mask = (idx[:, None] - idx[None, :] >= 0) & (idx[:, None] - idx[None, :] < window)
    scores = torch.where(mask[None, None], scores, -1e9)
    p = _softmax(scores, axis=-1)
    return torch.einsum("bhqk,bhkd->bhqd", p, v)
```

```asm
; @launch grid=(256,1,1) block=(512,1,1) lds=125952
.amdgcn_target "amdgcn-amd-amdhsa--gfx950"
.text
.globl standalone__sliding_window_attn__prompt_kernel
.p2align 8
.type standalone__sliding_window_attn__prompt_kernel,@function
standalone__sliding_window_attn__prompt_kernel:
    s_cmp_ge_u32 s2, 256
    s_cbranch_scc1 L_end
    s_load_dwordx4 s[4:7], s[0:1], 0
    s_load_dwordx2 s[8:9], s[0:1], 16
    s_load_dwordx2 s[10:11], s[0:1], 32
    s_getpc_b64 s[26:27]
L_pc:
    v_lshlrev_b32 v2, 6, v0
    v_min_u32 v2, L_code_end-L_pc-4, v2
    v_mov_b32 v3, s27
    v_add_co_u32 v2, vcc, s26, v2
    v_lshrrev_b32 v1, 6, v0
    v_and_b32 v254, 63, v0
    v_addc_co_u32 v3, vcc, 0, v3, vcc
    global_load_dword v253, v[2:3], off
    v_readfirstlane_b32 s20, v1
    v_lshrrev_b32 v4, 1, v0
    v_and_b32 v4, 28, v4
    v_lshrrev_b32 v5, 5, v0
    v_and_b32 v5, 2, v5
    v_xor_b32 v5, v254, v5
    s_mov_b32 s48, 0x44000000
    s_mov_b32 s49, 0x11114444
    s_mov_b32 s50, 0x55555511
    s_and_b32 s39, s20, 3
    s_mul_i32 s39, s39, 3072
    v_bfe_u32 v6, s48, v4, 3
    v_bfe_u32 v7, s49, v4, 3
    v_bfe_u32 v8, s50, v4, 3
    v_xor_b32 v6, v5, v6
    v_xor_b32 v7, v5, v7
    v_xor_b32 v8, v5, v8
    v_lshl_add_u32 v240, v6, 4, s39
    v_lshl_add_u32 v241, v7, 4, s39
    v_lshl_add_u32 v242, v8, 4, s39
    s_and_b32 s37, s2, 7
    s_lshr_b32 s38, s2, 6
    s_lshl_b32 s37, s37, 2
    s_add_u32 s37, s37, s38
    s_mov_b32 s83, 786432
    s_mul_i32 s44, s37, s83
    s_and_b32 s43, s2, 56
    s_bfe_u32 s40, s2, 0x10003
    s_add_u32 s42, s43, 7
    s_sub_u32 s41, s43, 8
    s_mov_b32 s22, 12288
    s_cmp_eq_u32 s40, 1
    s_cselect_b32 s41, s41, s42
    s_cselect_b32 s42, s43, s42
    s_mul_i32 s28, s41, s22
    s_mul_i32 s42, s42, s22
    s_cmp_ge_u32 s20, 4
    s_cselect_b32 s21, s42, s28
    s_cselect_b32 s32, s22, 0
    s_add_u32 s32, s32, s39
    s_mov_b32 m0, s32
    s_mov_b32 s14, s83
    s_mov_b32 s15, 0x20000
    s_cmp_ge_u32 s20, 4
    s_waitcnt lgkmcnt(0)
    s_cselect_b64 s[12:13], s[4:5], s[6:7]
    s_add_u32 s12, s12, s44
    s_addc_u32 s13, s13, 0
    buffer_load_dwordx4 v240, s[12:15], s21 offen lds
    buffer_load_dwordx4 v241, s[12:15], s21 offen offset:1024 lds
    buffer_load_dwordx4 v242, s[12:15], s21 offen offset:2048 lds
    s_cmp_eq_u32 s40, 1
    s_cselect_b32 s22, s22, 0xffffd000
    s_cselect_b32 s23, 0xfff40000, s83
    s_mov_b32 s30, 24576
    s_add_u32 s21, s21, s22
    s_add_u32 s32, s32, s30
    s_mov_b32 m0, s32
    s_barrier
    buffer_load_dwordx4 v240, s[12:15], s21 offen lds
    buffer_load_dwordx4 v241, s[12:15], s21 offen offset:1024 lds
    buffer_load_dwordx4 v242, s[12:15], s21 offen offset:2048 lds
    s_add_u32 s21, s21, s22
    s_add_u32 s32, s32, s30
    s_mov_b32 m0, s32
    s_barrier
    buffer_load_dwordx4 v240, s[12:15], s21 offen lds
    buffer_load_dwordx4 v241, s[12:15], s21 offen offset:1024 lds
    buffer_load_dwordx4 v242, s[12:15], s21 offen offset:2048 lds
    s_add_u32 s21, s21, s22
    s_add_u32 s32, s32, s30
    s_sub_u32 s47, 7, s20
    s_cmp_eq_u32 s40, 1
    s_cselect_b32 s47, s20, s47
    s_add_u32 s47, s47, s43
    s_mul_i32 s47, s47, 12288
    s_add_u32 s47, s47, s44
    s_mov_b32 s36, 0xffff
    s_cmp_eq_u32 s43, 0
    s_cselect_b32 s36, 0xff, s36
    s_mov_b32 s41, 0xffff
    s_lshl_b32 s24, s41, 9
    s_or_b32 s24, s24, 0xff
    s_lshr_b32 s36, s36, s20
    s_cmp_ge_u32 s20, 4
    s_cselect_b32 s24, s24, s41
    s_cselect_b32 s29, 0x200, 0
    s_cselect_b32 s87, 0xff, 0
    s_mov_b32 s25, 0x21084210
    s_mov_b32 s31, 0xfffe8000
    s_mov_b32 s33, 122880
    s_mov_b32 s19, 0x20000
    s_mov_b32 s18, 12288
    s_add_u32 s26, s8, s44
    s_addc_u32 s27, s9, 0
    s_add_u32 s16, s10, s47
    s_addc_u32 s17, s11, 0
    s_mov_b32 s35, 0x3dd53b95
    s_mov_b32 s45, 3072
    s_mov_b32 s46, 6144
    s_sub_u32 s37, s20, 5
    s_cmp_ge_u32 s20, 5
    s_cselect_b32 s37, s37, s20
    s_mul_i32 s47, s37, 24576
    s_add_u32 s37, s37, 4
    s_sub_u32 s38, s37, 5
    s_cmp_ge_u32 s37, 5
    s_cselect_b32 s37, s38, s37
    s_mul_i32 s34, s37, 24576
    v_and_b32 v1, 31, v254
    v_lshrrev_b32 v2, 5, v254
    v_bfe_u32 v3, v1, 1, 1
    v_bfe_u32 v4, v1, 2, 2
    v_lshl_or_b32 v3, v3, 2, v4
    v_xor_b32 v3, v3, v2
    v_lshlrev_b32 v3, 4, v3
    v_mul_u32_u24 v4, 384, v1
    v_add3_u32 v243, v3, v4, s47
    v_xor_b32 v244, 32, v243
    v_xor_b32 v245, 64, v243
    v_xor_b32 v246, 96, v243
    v_lshlrev_b32 v5, 2, v2
    v_sub_u32 v5, v1, v5
    v_bfe_u32 v6, v254, 2, 2
    v_lshl_add_u32 v7, v2, 2, v6
    v_mul_u32_u24 v7, 384, v7
    v_lshrrev_b32 v8, 1, v6
    v_lshl_or_b32 v8, v8, 2, v2
    v_bfe_u32 v9, v254, 4, 1
    v_bfe_u32 v10, v254, 1, 1
    v_lshl_or_b32 v9, v9, 1, v10
    v_xor_b32 v8, v8, v9
    v_lshl_add_u32 v7, v8, 4, v7
    v_and_b32 v10, 1, v254
    v_lshl_add_u32 v247, v10, 3, v7
    v_cmp_gt_i32 s[48:49], 0, v5
    v_cmp_gt_i32 s[50:51], 1, v5
    v_cmp_gt_i32 s[52:53], 2, v5
    v_cmp_gt_i32 s[54:55], 3, v5
    v_cmp_gt_i32 s[56:57], 8, v5
    v_cmp_gt_i32 s[58:59], 9, v5
    v_cmp_gt_i32 s[60:61], 10, v5
    v_cmp_gt_i32 s[62:63], 11, v5
    v_cmp_gt_i32 s[64:65], 16, v5
    v_cmp_gt_i32 s[66:67], 17, v5
    v_cmp_gt_i32 s[68:69], 18, v5
    v_cmp_gt_i32 s[70:71], 19, v5
    v_cmp_gt_i32 s[72:73], 24, v5
    v_cmp_gt_i32 s[74:75], 25, v5
    v_cmp_gt_i32 s[76:77], 26, v5
    v_cmp_gt_i32 s[78:79], 27, v5
    s_cmp_eq_u32 s40, 1
    s_cselect_b32 s37, 0, 0xf149f2ca
    s_cselect_b32 s38, 0xf149f2ca, 0
    v_mov_b32 v250, s37
    v_mov_b32 v251, s38
    v_mov_b32 v248, 0xdd5e0b6b
    v_mov_b32 v249, 0
    v_cndmask_b32 v0, v251, v250, s[48:49]
    v_cndmask_b32 v128, v250, v251, s[48:49]
    v_cndmask_b32 v1, v251, v250, s[50:51]
    v_cndmask_b32 v129, v250, v251, s[50:51]
    v_cndmask_b32 v2, v251, v250, s[52:53]
    v_cndmask_b32 v130, v250, v251, s[52:53]
    v_cndmask_b32 v3, v251, v250, s[54:55]
    v_cndmask_b32 v131, v250, v251, s[54:55]
    v_cndmask_b32 v4, v251, v250, s[56:57]
    v_cndmask_b32 v132, v250, v251, s[56:57]
    v_cndmask_b32 v5, v251, v250, s[58:59]
    v_cndmask_b32 v133, v250, v251, s[58:59]
    v_cndmask_b32 v6, v251, v250, s[60:61]
    v_cndmask_b32 v134, v250, v251, s[60:61]
    v_cndmask_b32 v7, v251, v250, s[62:63]
    v_cndmask_b32 v135, v250, v251, s[62:63]
    v_cndmask_b32 v8, v251, v250, s[64:65]
    v_cndmask_b32 v136, v250, v251, s[64:65]
    v_cndmask_b32 v9, v251, v250, s[66:67]
    v_cndmask_b32 v137, v250, v251, s[66:67]
    v_cndmask_b32 v10, v251, v250, s[68:69]
    v_cndmask_b32 v138, v250, v251, s[68:69]
    v_cndmask_b32 v11, v251, v250, s[70:71]
    v_cndmask_b32 v139, v250, v251, s[70:71]
    v_cndmask_b32 v12, v251, v250, s[72:73]
    v_cndmask_b32 v140, v250, v251, s[72:73]
    v_cndmask_b32 v13, v251, v250, s[74:75]
    v_cndmask_b32 v141, v250, v251, s[74:75]
    v_cndmask_b32 v14, v251, v250, s[76:77]
    v_cndmask_b32 v142, v250, v251, s[76:77]
    v_cndmask_b32 v15, v251, v250, s[78:79]
    v_cndmask_b32 v143, v250, v251, s[78:79]
    s_and_b32 s37, s2, 56
    s_cmp_lg_u32 s37, 0
    s_cselect_b32 s37, s20, 7
    s_cmp_ge_u32 s37, 4
    s_cselect_b64 vcc, -1, 0
    s_mov_b64 exec, 0
    s_branch L_qk1b
L_warm1:
    s_branch L_pv5b
L_warm2:
    s_mov_b64 exec, -1
    s_cmp_eq_u32 s20, 0
    s_cbranch_scc1 L_pre
    s_mov_b32 s43, s20
L_idle:
    s_waitcnt vmcnt(6)
    s_barrier
    s_bitcmp1_b32 s29, 3
    s_cselect_b64 s[12:13], s[26:27], s[12:13]
    s_cselect_b32 s21, s28, s21
    s_bitcmp1_b32 s24, 3
    s_cselect_b32 m0, s32, s33
    s_cselect_b32 s14, s83, 0
    s_bitcmp1_b32 s87, 3
    s_cbranch_scc1 L_q1
    buffer_load_dwordx4 v240, s[12:15], s21 offen lds
    buffer_load_dwordx4 v241, s[12:15], s21 offen offset:1024 lds
    buffer_load_dwordx4 v242, s[12:15], s21 offen offset:2048 lds
    s_branch L_qd1
L_q1:
    buffer_load_dwordx4 v240, s[12:15], s21 offen nt lds
    buffer_load_dwordx4 v241, s[12:15], s21 offen offset:1024 nt lds
    buffer_load_dwordx4 v242, s[12:15], s21 offen offset:2048 nt lds
L_qd1:
    s_add_u32 s21, s21, s22
    s_add_u32 s37, s21, s23
    s_min_u32 s21, s21, s37
    s_bitcmp1_b32 s25, 3
    s_cselect_b32 s37, s31, s30
    s_add_u32 s32, s32, s37
    s_lshr_b32 s24, s24, 1
    s_lshr_b32 s25, s25, 1
    s_lshr_b32 s29, s29, 1
    s_lshr_b32 s87, s87, 1
    s_sub_u32 s43, s43, 1
    s_cmp_lg_u32 s43, 0
    s_cbranch_scc1 L_idle
L_pre:
    s_waitcnt vmcnt(6)
    s_barrier
    ds_read_b128 v[144:147], v243 offset:12288
    ds_read_b128 v[148:151], v244 offset:12288
    ds_read_b128 v[152:155], v245 offset:12288
    ds_read_b128 v[156:159], v246 offset:12288
    ds_read_b128 v[160:163], v243 offset:12416
    ds_read_b128 v[164:167], v244 offset:12416
    ds_read_b128 v[168:171], v245 offset:12416
    ds_read_b128 v[172:175], v246 offset:12416
    ds_read_b128 v[176:179], v243 offset:12544
    ds_read_b128 v[180:183], v244 offset:12544
    ds_read_b128 v[184:187], v245 offset:12544
    ds_read_b128 v[188:191], v246 offset:12544
    s_bitcmp1_b32 s29, 3
    s_cselect_b64 s[12:13], s[26:27], s[12:13]
    s_cselect_b32 s21, s28, s21
    s_bitcmp1_b32 s24, 3
    s_cselect_b32 m0, s32, s33
    s_cselect_b32 s14, s83, 0
    s_bitcmp1_b32 s87, 3
    s_cbranch_scc1 L_q2
    buffer_load_dwordx4 v240, s[12:15], s21 offen lds
    buffer_load_dwordx4 v241, s[12:15], s21 offen offset:1024 lds
    buffer_load_dwordx4 v242, s[12:15], s21 offen offset:2048 lds
    s_branch L_qd2
L_q2:
    buffer_load_dwordx4 v240, s[12:15], s21 offen nt lds
    buffer_load_dwordx4 v241, s[12:15], s21 offen offset:1024 nt lds
    buffer_load_dwordx4 v242, s[12:15], s21 offen offset:2048 nt lds
L_qd2:
    s_add_u32 s21, s21, s22
    s_add_u32 s37, s21, s23
    s_min_u32 s21, s21, s37
    s_bitcmp1_b32 s25, 3
    s_cselect_b32 s37, s31, s30
    s_add_u32 s32, s32, s37
    ds_read_b128 v[192:195], v243 offset:0
    ds_read_b128 v[196:199], v244 offset:0
    ds_read_b128 v[200:203], v245 offset:0
    s_waitcnt lgkmcnt(14)
    ds_read_b128 v[204:207], v246 offset:0
    s_waitcnt lgkmcnt(14)
    ds_read_b128 v[208:211], v243 offset:128
    s_waitcnt lgkmcnt(14)
    ds_read_b128 v[212:215], v244 offset:128
    s_waitcnt lgkmcnt(14)
    ds_read_b128 v[216:219], v245 offset:128
    s_waitcnt lgkmcnt(14)
    ds_read_b128 v[220:223], v246 offset:128
    s_waitcnt lgkmcnt(14)
    ds_read_b128 v[224:227], v243 offset:256
    s_waitcnt lgkmcnt(14)
    ds_read_b128 v[228:231], v244 offset:256
    s_waitcnt lgkmcnt(14)
    ds_read_b128 v[232:235], v245 offset:256
    s_waitcnt lgkmcnt(14)
    ds_read_b128 v[236:239], v246 offset:256
    s_bitcmp1_b32 s25, 0
    s_cselect_b32 s44, s31, s30
    v_add_u32 v243, s44, v243
    v_add_u32 v244, s44, v244
    v_add_u32 v245, s44, v245
    v_add_u32 v246, s44, v246
    s_waitcnt vmcnt(6)
    s_barrier
L_qk0:
    s_waitcnt lgkmcnt(11)
    v_mfma_f32_32x32x16_bf16 v[0:15], v[192:195], v[144:147], v[0:15]
    ds_read_b128 v[192:195], v243 offset:0
    s_waitcnt lgkmcnt(11)
    v_mfma_f32_32x32x16_bf16 v[0:15], v[196:199], v[148:151], v[0:15]
    ds_read_b128 v[196:199], v244 offset:0
    s_bitcmp1_b32 s29, 4
    s_cselect_b64 s[12:13], s[26:27], s[12:13]
    s_cselect_b32 s21, s28, s21
    s_waitcnt lgkmcnt(11)
    v_mfma_f32_32x32x16_bf16 v[0:15], v[200:203], v[152:155], v[0:15]
    ds_read_b128 v[200:203], v245 offset:0
    s_bitcmp1_b32 s24, 4
    s_cselect_b32 m0, s32, s33
    s_cselect_b32 s14, s83, 0
    buffer_load_dwordx4 v240, s[12:15], s21 offen lds
    s_waitcnt lgkmcnt(11)
    v_mfma_f32_32x32x16_bf16 v[0:15], v[204:207], v[156:159], v[0:15]
    ds_read_b128 v[204:207], v246 offset:0
    buffer_load_dwordx4 v241, s[12:15], s21 offen offset:1024 lds
    s_waitcnt lgkmcnt(11)
    v_mfma_f32_32x32x16_bf16 v[0:15], v[208:211], v[160:163], v[0:15]
    ds_read_b128 v[208:211], v243 offset:128
    buffer_load_dwordx4 v242, s[12:15], s21 offen offset:2048 lds
    s_waitcnt lgkmcnt(11)
    v_mfma_f32_32x32x16_bf16 v[0:15], v[212:215], v[164:167], v[0:15]
    ds_read_b128 v[212:215], v244 offset:128
    s_add_u32 s21, s21, s22
    s_add_u32 s37, s21, s23
    s_min_u32 s21, s21, s37
    s_waitcnt lgkmcnt(11)
    v_mfma_f32_32x32x16_bf16 v[0:15], v[216:219], v[168:171], v[0:15]
    ds_read_b128 v[216:219], v245 offset:128
    s_bitcmp1_b32 s25, 4
    s_cselect_b32 s37, s31, s30
    s_add_u32 s32, s32, s37
    s_waitcnt lgkmcnt(11)
    v_mfma_f32_32x32x16_bf16 v[0:15], v[220:223], v[172:175], v[0:15]
    ds_read_b128 v[220:223], v246 offset:128
    s_waitcnt lgkmcnt(11)
    v_mfma_f32_32x32x16_bf16 v[0:15], v[224:227], v[176:179], v[0:15]
    ds_read_b128 v[224:227], v243 offset:256
    s_waitcnt lgkmcnt(11)
    v_mfma_f32_32x32x16_bf16 v[0:15], v[228:231], v[180:183], v[0:15]
    ds_read_b128 v[228:231], v244 offset:256
    s_waitcnt lgkmcnt(11)
    v_mfma_f32_32x32x16_bf16 v[0:15], v[232:235], v[184:187], v[0:15]
    ds_read_b128 v[232:235], v245 offset:256
    s_bitcmp1_b32 s25, 1
    s_cselect_b32 s44, s31, s30
    s_waitcnt lgkmcnt(11)
    v_mfma_f32_32x32x16_bf16 v[0:15], v[236:239], v[188:191], v[0:15]
    s_waitcnt vmcnt(6)
    s_barrier
    ds_read_b128 v[236:239], v246 offset:256
L_qk1:
    s_cbranch_vccnz L_qk1b
    s_waitcnt lgkmcnt(6)
    v_mfma_f32_32x32x16_bf16 v[16:31], v[192:195], v[144:147], 0
    v_add_u32 v243, s44, v243
    v_add_u32 v244, s44, v244
    v_add_u32 v245, s44, v245
    v_add_u32 v246, s44, v246
    ds_read_b128 v[192:195], v243 offset:0
    v_mfma_f32_32x32x16_bf16 v[16:31], v[196:199], v[148:151], v[16:31]
    ds_read_b128 v[196:199], v244 offset:0
    s_bitcmp1_b32 s29, 5
    s_cselect_b64 s[12:13], s[26:27], s[12:13]
    s_cselect_b32 s21, s28, s21
    v_mfma_f32_32x32x16_bf16 v[16:31], v[200:203], v[152:155], v[16:31]
    v_max3_f32 v248, v248, v0, v1
    v_max3_f32 v248, v248, v2, v3
    ds_read_b128 v[200:203], v245 offset:0
    s_bitcmp1_b32 s24, 5
    s_cselect_b32 m0, s32, s33
    s_cselect_b32 s14, s83, 0
    buffer_load_dwordx4 v240, s[12:15], s21 offen lds
    v_mfma_f32_32x32x16_bf16 v[16:31], v[204:207], v[156:159], v[16:31]
    v_max3_f32 v248, v248, v4, v5
    v_max3_f32 v248, v248, v6, v7
    v_max3_f32 v248, v248, v8, v9
    ds_read_b128 v[204:207], v246 offset:0
    buffer_load_dwordx4 v241, s[12:15], s21 offen offset:1024 lds
    v_mfma_f32_32x32x16_bf16 v[16:31], v[208:211], v[160:163], v[16:31]
    v_max3_f32 v248, v248, v10, v11
    v_max3_f32 v248, v248, v12, v13
    v_max3_f32 v248, v248, v14, v15
    ds_read_b128 v[208:211], v243 offset:128
    buffer_load_dwordx4 v242, s[12:15], s21 offen offset:2048 lds
    v_mfma_f32_32x32x16_bf16 v[16:31], v[212:215], v[164:167], v[16:31]
    ds_read_b128 v[212:215], v244 offset:128
    s_add_u32 s21, s21, s22
    s_add_u32 s37, s21, s23
    s_min_u32 s21, s21, s37
    s_waitcnt lgkmcnt(6)
    v_mfma_f32_32x32x16_bf16 v[16:31], v[216:219], v[168:171], v[16:31]
    ds_read_b128 v[216:219], v245 offset:128
    s_bitcmp1_b32 s25, 5
    s_cselect_b32 s37, s31, s30
    s_add_u32 s32, s32, s37
    v_mfma_f32_32x32x16_bf16 v[16:31], v[220:223], v[172:175], v[16:31]
    ds_read_b128 v[220:223], v246 offset:128
    v_mfma_f32_32x32x16_bf16 v[16:31], v[224:227], v[176:179], v[16:31]
    ds_read_b128 v[224:227], v243 offset:256
    v_mfma_f32_32x32x16_bf16 v[16:31], v[228:231], v[180:183], v[16:31]
    ds_read_b128 v[228:231], v244 offset:256
    v_mfma_f32_32x32x16_bf16 v[16:31], v[232:235], v[184:187], v[16:31]
    ds_read_b128 v[232:235], v245 offset:256
    s_bitcmp1_b32 s25, 2
    s_cselect_b32 s44, s31, s30
    v_mfma_f32_32x32x16_bf16 v[16:31], v[236:239], v[188:191], v[16:31]
    s_waitcnt vmcnt(6)
    s_barrier
    ds_read_b128 v[236:239], v246 offset:256
L_qk2:
    s_waitcnt lgkmcnt(6)
    v_mfma_f32_32x32x16_bf16 v[32:47], v[192:195], v[144:147], 0
    v_add_u32 v243, s44, v243
    v_add_u32 v244, s44, v244
    v_add_u32 v245, s44, v245
    v_add_u32 v246, s44, v246
    ds_read_b128 v[192:195], v243 offset:0
    v_mfma_f32_32x32x16_bf16 v[32:47], v[196:199], v[148:151], v[32:47]
    ds_read_b128 v[196:199], v244 offset:0
    v_mfma_f32_32x32x16_bf16 v[32:47], v[200:203], v[152:155], v[32:47]
    v_max3_f32 v248, v248, v16, v17
    v_max3_f32 v248, v248, v18, v19
    ds_read_b128 v[200:203], v245 offset:0
    s_bitcmp1_b32 s24, 6
    s_cselect_b32 m0, s32, s33
    s_cselect_b32 s14, s83, 0
    buffer_load_dwordx4 v240, s[12:15], s21 offen lds
    v_mfma_f32_32x32x16_bf16 v[32:47], v[204:207], v[156:159], v[32:47]
    v_max3_f32 v248, v248, v20, v21
    v_max3_f32 v248, v248, v22, v23
    v_max3_f32 v248, v248, v24, v25
    ds_read_b128 v[204:207], v246 offset:0
    buffer_load_dwordx4 v241, s[12:15], s21 offen offset:1024 lds
    v_mfma_f32_32x32x16_bf16 v[32:47], v[208:211], v[160:163], v[32:47]
    v_max3_f32 v248, v248, v26, v27
    v_max3_f32 v248, v248, v28, v29
    v_max3_f32 v248, v248, v30, v31
    ds_read_b128 v[208:211], v243 offset:128
    buffer_load_dwordx4 v242, s[12:15], s21 offen offset:2048 lds
    v_mfma_f32_32x32x16_bf16 v[32:47], v[212:215], v[164:167], v[32:47]
    ds_read_b128 v[212:215], v244 offset:128
    s_add_u32 s21, s21, s22
    s_add_u32 s37, s21, s23
    s_min_u32 s21, s21, s37
    s_waitcnt lgkmcnt(6)
    v_mfma_f32_32x32x16_bf16 v[32:47], v[216:219], v[168:171], v[32:47]
    ds_read_b128 v[216:219], v245 offset:128
    s_bitcmp1_b32 s25, 6
    s_cselect_b32 s37, s31, s30
    s_add_u32 s32, s32, s37
    v_mfma_f32_32x32x16_bf16 v[32:47], v[220:223], v[172:175], v[32:47]
    ds_read_b128 v[220:223], v246 offset:128
    v_mfma_f32_32x32x16_bf16 v[32:47], v[224:227], v[176:179], v[32:47]
    ds_read_b128 v[224:227], v243 offset:256
    v_mfma_f32_32x32x16_bf16 v[32:47], v[228:231], v[180:183], v[32:47]
    ds_read_b128 v[228:231], v244 offset:256
    v_mfma_f32_32x32x16_bf16 v[32:47], v[232:235], v[184:187], v[32:47]
    ds_read_b128 v[232:235], v245 offset:256
    s_bitcmp1_b32 s25, 3
    s_cselect_b32 s44, s31, s30
    v_mfma_f32_32x32x16_bf16 v[32:47], v[236:239], v[188:191], v[32:47]
    s_waitcnt vmcnt(6)
    s_barrier
    ds_read_b128 v[236:239], v246 offset:256
L_qk3:
    s_waitcnt lgkmcnt(6)
    v_mfma_f32_32x32x16_bf16 v[48:63], v[192:195], v[144:147], 0
    v_add_u32 v243, s44, v243
    v_add_u32 v244, s44, v244
    v_add_u32 v245, s44, v245
    v_add_u32 v246, s44, v246
    ds_read_b128 v[192:195], v243 offset:0
    v_mfma_f32_32x32x16_bf16 v[48:63], v[196:199], v[148:151], v[48:63]
    ds_read_b128 v[196:199], v244 offset:0
    v_mfma_f32_32x32x16_bf16 v[48:63], v[200:203], v[152:155], v[48:63]
    v_max3_f32 v248, v248, v32, v33
    v_max3_f32 v248, v248, v34, v35
    ds_read_b128 v[200:203], v245 offset:0
    s_bitcmp1_b32 s24, 7
    s_cselect_b32 m0, s32, s33
    s_cselect_b32 s14, s83, 0
    buffer_load_dwordx4 v240, s[12:15], s21 offen lds
    v_mfma_f32_32x32x16_bf16 v[48:63], v[204:207], v[156:159], v[48:63]
    v_max3_f32 v248, v248, v36, v37
    v_max3_f32 v248, v248, v38, v39
    v_max3_f32 v248, v248, v40, v41
    ds_read_b128 v[204:207], v246 offset:0
    buffer_load_dwordx4 v241, s[12:15], s21 offen offset:1024 lds
    v_mfma_f32_32x32x16_bf16 v[48:63], v[208:211], v[160:163], v[48:63]
    v_max3_f32 v248, v248, v42, v43
    v_max3_f32 v248, v248, v44, v45
    v_max3_f32 v248, v248, v46, v47
    ds_read_b128 v[208:211], v243 offset:128
    buffer_load_dwordx4 v242, s[12:15], s21 offen offset:2048 lds
    v_mfma_f32_32x32x16_bf16 v[48:63], v[212:215], v[164:167], v[48:63]
    ds_read_b128 v[212:215], v244 offset:128
    s_add_u32 s21, s21, s22
    s_add_u32 s37, s21, s23
    s_min_u32 s21, s21, s37
    s_waitcnt lgkmcnt(6)
    v_mfma_f32_32x32x16_bf16 v[48:63], v[216:219], v[168:171], v[48:63]
    ds_read_b128 v[216:219], v245 offset:128
    s_bitcmp1_b32 s25, 7
    s_cselect_b32 s37, s31, s30
    s_add_u32 s32, s32, s37
    v_mfma_f32_32x32x16_bf16 v[48:63], v[220:223], v[172:175], v[48:63]
    ds_read_b128 v[220:223], v246 offset:128
    v_mfma_f32_32x32x16_bf16 v[48:63], v[224:227], v[176:179], v[48:63]
    ds_read_b128 v[224:227], v243 offset:256
    v_mfma_f32_32x32x16_bf16 v[48:63], v[228:231], v[180:183], v[48:63]
    ds_read_b128 v[228:231], v244 offset:256
    v_mfma_f32_32x32x16_bf16 v[48:63], v[232:235], v[184:187], v[48:63]
    ds_read_b128 v[232:235], v245 offset:256
    s_bitcmp1_b32 s25, 4
    s_cselect_b32 s44, s31, s30
    v_mfma_f32_32x32x16_bf16 v[48:63], v[236:239], v[188:191], v[48:63]
    s_waitcnt vmcnt(6)
    s_barrier
    ds_read_b128 v[236:239], v246 offset:256
L_qk4:
    s_waitcnt lgkmcnt(6)
    v_mfma_f32_32x32x16_bf16 v[64:79], v[192:195], v[144:147], 0
    v_add_u32 v243, s44, v243
    v_add_u32 v244, s44, v244
    v_add_u32 v245, s44, v245
    v_add_u32 v246, s44, v246
    ds_read_b128 v[192:195], v243 offset:0
    v_mfma_f32_32x32x16_bf16 v[64:79], v[196:199], v[148:151], v[64:79]
    ds_read_b128 v[196:199], v244 offset:0
    v_mfma_f32_32x32x16_bf16 v[64:79], v[200:203], v[152:155], v[64:79]
    v_max3_f32 v248, v248, v48, v49
    v_max3_f32 v248, v248, v50, v51
    v_max3_f32 v248, v248, v52, v53
    ds_read_b128 v[200:203], v245 offset:0
    s_bitcmp1_b32 s24, 8
    s_cselect_b32 m0, s32, s33
    s_cselect_b32 s14, s83, 0
    buffer_load_dwordx4 v240, s[12:15], s21 offen lds
    v_mfma_f32_32x32x16_bf16 v[64:79], v[204:207], v[156:159], v[64:79]
    v_max3_f32 v248, v248, v54, v55
    v_max3_f32 v248, v248, v56, v57
    v_max3_f32 v248, v248, v58, v59
    ds_read_b128 v[204:207], v246 offset:0
    buffer_load_dwordx4 v241, s[12:15], s21 offen offset:1024 lds
    v_mfma_f32_32x32x16_bf16 v[64:79], v[208:211], v[160:163], v[64:79]
    v_max3_f32 v248, v248, v60, v61
    v_max3_f32 v248, v248, v62, v63
    v_mul_f32 v251, s35, v248
    v_mul_f32 v252, s35, v248
    ds_read_b128 v[208:211], v243 offset:128
    buffer_load_dwordx4 v242, s[12:15], s21 offen offset:2048 lds
    v_mfma_f32_32x32x16_bf16 v[64:79], v[212:215], v[164:167], v[64:79]
    v_fma_f32 v0, v0, s35, -v251
    v_fma_f32 v1, v1, s35, -v251
    v_exp_f32 v0, v0
    v_exp_f32 v1, v1
    v_fma_f32 v2, v2, s35, -v251
    v_add_f32 v249, v249, v0
    v_fma_f32 v3, v3, s35, -v251
    v_add_f32 v249, v249, v1
    v_exp_f32 v2, v2
    v_exp_f32 v3, v3
    v_fma_f32 v4, v4, s35, -v251
    v_add_f32 v249, v249, v2
    v_fma_f32 v5, v5, s35, -v251
    v_add_f32 v249, v249, v3
    v_exp_f32 v4, v4
    v_exp_f32 v5, v5
    v_fma_f32 v6, v6, s35, -v251
    v_add_f32 v249, v249, v4
    v_fma_f32 v7, v7, s35, -v251
    v_add_f32 v249, v249, v5
    v_exp_f32 v6, v6
    v_exp_f32 v7, v7
    v_fma_f32 v8, v8, s35, -v251
    v_add_f32 v249, v249, v6
    v_fma_f32 v9, v9, s35, -v251
    v_add_f32 v249, v249, v7
    v_exp_f32 v8, v8
    ds_read_b128 v[212:215], v244 offset:128
    s_add_u32 s21, s21, s22
    s_add_u32 s37, s21, s23
    s_min_u32 s21, s21, s37
    s_waitcnt lgkmcnt(6)
    v_mfma_f32_32x32x16_bf16 v[64:79], v[216:219], v[168:171], v[64:79]
    v_exp_f32 v9, v9
    v_fma_f32 v10, v10, s35, -v251
    v_add_f32 v249, v249, v8
    v_fma_f32 v11, v11, s35, -v251
    v_add_f32 v249, v249, v9
    v_exp_f32 v10, v10
    v_exp_f32 v11, v11
    v_fma_f32 v12, v12, s35, -v251
    v_add_f32 v249, v249, v10
    v_fma_f32 v13, v13, s35, -v251
    v_add_f32 v249, v249, v11
    v_exp_f32 v12, v12
    v_exp_f32 v13, v13
    v_fma_f32 v14, v14, s35, -v251
    v_add_f32 v249, v249, v12
    v_fma_f32 v15, v15, s35, -v251
    v_add_f32 v249, v249, v13
    v_exp_f32 v14, v14
    v_exp_f32 v15, v15
    v_add_f32 v249, v249, v14
    v_add_f32 v249, v249, v15
    v_fma_f32 v16, v16, s35, -v251
    v_fma_f32 v17, v17, s35, -v251
    v_exp_f32 v16, v16
    v_exp_f32 v17, v17
    v_fma_f32 v18, v18, s35, -v251
    v_add_f32 v249, v249, v16
    v_fma_f32 v19, v19, s35, -v251
    ds_read_b128 v[216:219], v245 offset:128
    s_bitcmp1_b32 s25, 8
    s_cselect_b32 s37, s31, s30
    s_add_u32 s32, s32, s37
    v_mfma_f32_32x32x16_bf16 v[64:79], v[220:223], v[172:175], v[64:79]
    v_add_f32 v249, v249, v17
    v_exp_f32 v18, v18
    v_exp_f32 v19, v19
    v_fma_f32 v20, v20, s35, -v251
    v_add_f32 v249, v249, v18
    v_fma_f32 v21, v21, s35, -v251
    v_add_f32 v249, v249, v19
    v_exp_f32 v20, v20
    v_exp_f32 v21, v21
    v_fma_f32 v22, v22, s35, -v251
    v_add_f32 v249, v249, v20
    v_fma_f32 v23, v23, s35, -v251
    v_add_f32 v249, v249, v21
    v_exp_f32 v22, v22
    v_exp_f32 v23, v23
    v_fma_f32 v24, v24, s35, -v251
    v_add_f32 v249, v249, v22
    v_fma_f32 v25, v25, s35, -v251
    v_add_f32 v249, v249, v23
    v_exp_f32 v24, v24
    v_exp_f32 v25, v25
    v_fma_f32 v26, v26, s35, -v251
    v_add_f32 v249, v249, v24
    v_fma_f32 v27, v27, s35, -v251
    v_add_f32 v249, v249, v25
    v_exp_f32 v26, v26
    v_exp_f32 v27, v27
    ds_read_b128 v[220:223], v246 offset:128
    v_mfma_f32_32x32x16_bf16 v[64:79], v[224:227], v[176:179], v[64:79]
    v_fma_f32 v28, v28, s35, -v251
    v_add_f32 v249, v249, v26
    v_fma_f32 v29, v29, s35, -v251
    v_add_f32 v249, v249, v27
    v_exp_f32 v28, v28
    v_exp_f32 v29, v29
    v_fma_f32 v30, v30, s35, -v251
    v_add_f32 v249, v249, v28
    v_fma_f32 v31, v31, s35, -v251
    v_add_f32 v249, v249, v29
    v_exp_f32 v30, v30
    v_exp_f32 v31, v31
    v_add_f32 v249, v249, v30
    v_add_f32 v249, v249, v31
    v_fma_f32 v32, v32, s35, -v252
    v_fma_f32 v33, v33, s35, -v252
    v_exp_f32 v32, v32
    v_exp_f32 v33, v33
    v_fma_f32 v34, v34, s35, -v252
    v_add_f32 v249, v249, v32
    v_fma_f32 v35, v35, s35, -v252
    v_add_f32 v249, v249, v33
    v_exp_f32 v34, v34
    v_exp_f32 v35, v35
    v_fma_f32 v36, v36, s35, -v252
    v_add_f32 v249, v249, v34
    v_fma_f32 v37, v37, s35, -v252
    v_add_f32 v249, v249, v35
    ds_read_b128 v[224:227], v243 offset:256
    v_mfma_f32_32x32x16_bf16 v[64:79], v[228:231], v[180:183], v[64:79]
    v_exp_f32 v36, v36
    v_exp_f32 v37, v37
    v_fma_f32 v38, v38, s35, -v252
    v_add_f32 v249, v249, v36
    v_fma_f32 v39, v39, s35, -v252
    v_add_f32 v249, v249, v37
    v_exp_f32 v38, v38
    v_exp_f32 v39, v39
    v_fma_f32 v40, v40, s35, -v252
    v_add_f32 v249, v249, v38
    v_fma_f32 v41, v41, s35, -v252
    v_add_f32 v249, v249, v39
    v_exp_f32 v40, v40
    v_exp_f32 v41, v41
    v_fma_f32 v42, v42, s35, -v252
    v_add_f32 v249, v249, v40
    v_fma_f32 v43, v43, s35, -v252
    v_add_f32 v249, v249, v41
    v_exp_f32 v42, v42
    v_exp_f32 v43, v43
    v_fma_f32 v44, v44, s35, -v252
    v_add_f32 v249, v249, v42
    v_fma_f32 v45, v45, s35, -v252
    v_add_f32 v249, v249, v43
    v_exp_f32 v44, v44
    v_exp_f32 v45, v45
    v_fma_f32 v46, v46, s35, -v252
    ds_read_b128 v[228:231], v244 offset:256
    v_mfma_f32_32x32x16_bf16 v[64:79], v[232:235], v[184:187], v[64:79]
    v_add_f32 v249, v249, v44
    v_fma_f32 v47, v47, s35, -v252
    v_add_f32 v249, v249, v45
    v_exp_f32 v46, v46
    v_exp_f32 v47, v47
    v_add_f32 v249, v249, v46
    v_add_f32 v249, v249, v47
    v_fma_f32 v48, v48, s35, -v252
    v_fma_f32 v49, v49, s35, -v252
    v_exp_f32 v48, v48
    v_exp_f32 v49, v49
    v_fma_f32 v50, v50, s35, -v252
    v_add_f32 v249, v249, v48
    v_fma_f32 v51, v51, s35, -v252
    v_add_f32 v249, v249, v49
    v_exp_f32 v50, v50
    v_exp_f32 v51, v51
    v_fma_f32 v52, v52, s35, -v252
    v_add_f32 v249, v249, v50
    v_fma_f32 v53, v53, s35, -v252
    v_add_f32 v249, v249, v51
    v_exp_f32 v52, v52
    v_exp_f32 v53, v53
    v_fma_f32 v54, v54, s35, -v252
    v_add_f32 v249, v249, v52
    v_fma_f32 v55, v55, s35, -v252
    v_add_f32 v249, v249, v53
    v_exp_f32 v54, v54
    ds_read_b128 v[232:235], v245 offset:256
    s_bitcmp1_b32 s25, 5
    s_cselect_b32 s44, s31, s30
    v_mfma_f32_32x32x16_bf16 v[64:79], v[236:239], v[188:191], v[64:79]
    s_waitcnt vmcnt(6)
    s_barrier
    v_exp_f32 v55, v55
    v_fma_f32 v56, v56, s35, -v252
    v_add_f32 v249, v249, v54
    v_fma_f32 v57, v57, s35, -v252
    v_add_f32 v249, v249, v55
    v_exp_f32 v56, v56
    v_exp_f32 v57, v57
    v_fma_f32 v58, v58, s35, -v252
    v_add_f32 v249, v249, v56
    v_fma_f32 v59, v59, s35, -v252
    v_add_f32 v249, v249, v57
    v_exp_f32 v58, v58
    v_exp_f32 v59, v59
    v_fma_f32 v60, v60, s35, -v252
    v_add_f32 v249, v249, v58
    v_fma_f32 v61, v61, s35, -v252
    v_add_f32 v249, v249, v59
    v_exp_f32 v60, v60
    v_exp_f32 v61, v61
    v_fma_f32 v62, v62, s35, -v252
    v_add_f32 v249, v249, v60
    v_fma_f32 v63, v63, s35, -v252
    v_add_f32 v249, v249, v61
    v_exp_f32 v62, v62
    v_exp_f32 v63, v63
    v_add_f32 v249, v249, v62
    v_add_f32 v249, v249, v63
    ds_read_b128 v[236:239], v246 offset:256
L_qk5:
    s_waitcnt lgkmcnt(6)
    v_mfma_f32_32x32x16_bf16 v[80:95], v[192:195], v[144:147], 0
    v_add_u32 v243, s44, v243
    v_add_u32 v244, s44, v244
    v_add_u32 v245, s44, v245
    v_add_u32 v246, s44, v246
    ds_read_b128 v[192:195], v243 offset:0
    v_mfma_f32_32x32x16_bf16 v[80:95], v[196:199], v[148:151], v[80:95]
    ds_read_b128 v[196:199], v244 offset:0
    v_mfma_f32_32x32x16_bf16 v[80:95], v[200:203], v[152:155], v[80:95]
    v_max3_f32 v248, v248, v64, v65
    v_max3_f32 v248, v248, v66, v67
    v_max3_f32 v248, v248, v68, v69
    ds_read_b128 v[200:203], v245 offset:0
    s_bitcmp1_b32 s24, 9
    s_cselect_b32 m0, s32, s33
    s_cselect_b32 s14, s83, 0
    buffer_load_dwordx4 v240, s[12:15], s21 offen lds
    v_mfma_f32_32x32x16_bf16 v[80:95], v[204:207], v[156:159], v[80:95]
    v_max3_f32 v248, v248, v70, v71
    v_max3_f32 v248, v248, v72, v73
    v_max3_f32 v248, v248, v74, v75
    ds_read_b128 v[204:207], v246 offset:0
    buffer_load_dwordx4 v241, s[12:15], s21 offen offset:1024 lds
    v_mfma_f32_32x32x16_bf16 v[80:95], v[208:211], v[160:163], v[80:95]
    v_max3_f32 v248, v248, v76, v77
    v_max3_f32 v248, v248, v78, v79
    v_mul_f32 v253, s35, v248
    ds_read_b128 v[208:211], v243 offset:128
    buffer_load_dwordx4 v242, s[12:15], s21 offen offset:2048 lds
    v_mfma_f32_32x32x16_bf16 v[80:95], v[212:215], v[164:167], v[80:95]
    v_sub_f32 v250, v252, v253
    ds_read_b128 v[212:215], v244 offset:128
    s_add_u32 s21, s21, s22
    s_add_u32 s37, s21, s23
    s_min_u32 s21, s21, s37
    s_waitcnt lgkmcnt(6)
    v_mfma_f32_32x32x16_bf16 v[80:95], v[216:219], v[168:171], v[80:95]
    v_exp_f32 v250, v250
    v_fma_f32 v64, v64, s35, -v253
    ds_read_b128 v[216:219], v245 offset:128
    s_bitcmp1_b32 s25, 9
    s_cselect_b32 s37, s31, s30
    s_add_u32 s32, s32, s37
    v_mfma_f32_32x32x16_bf16 v[80:95], v[220:223], v[172:175], v[80:95]
    v_fma_f32 v65, v65, s35, -v253
    v_mul_f32 v249, v250, v249
    ds_read_b128 v[220:223], v246 offset:128
    v_mfma_f32_32x32x16_bf16 v[80:95], v[224:227], v[176:179], v[80:95]
    v_exp_f32 v64, v64
    ds_read_b128 v[224:227], v243 offset:256
    v_mfma_f32_32x32x16_bf16 v[80:95], v[228:231], v[180:183], v[80:95]
    v_exp_f32 v65, v65
    v_fma_f32 v66, v66, s35, -v253
    ds_read_b128 v[228:231], v244 offset:256
    v_mfma_f32_32x32x16_bf16 v[80:95], v[232:235], v[184:187], v[80:95]
    v_add_f32 v249, v249, v64
    v_fma_f32 v67, v67, s35, -v253
    ds_read_b128 v[232:235], v245 offset:256
    s_bitcmp1_b32 s25, 6
    s_cselect_b32 s44, s31, s30
    v_mfma_f32_32x32x16_bf16 v[80:95], v[236:239], v[188:191], v[80:95]
    s_waitcnt vmcnt(6)
    s_barrier
    v_add_f32 v249, v249, v65
    v_exp_f32 v66, v66
    ds_read_b128 v[236:239], v246 offset:256
L_qk6:
    s_waitcnt lgkmcnt(6)
    v_mfma_f32_32x32x16_bf16 v[96:111], v[192:195], v[144:147], 0
    v_add_u32 v243, s44, v243
    v_add_u32 v244, s44, v244
    v_add_u32 v245, s44, v245
    v_add_u32 v246, s44, v246
    ds_read_b128 v[192:195], v243 offset:0
    v_mfma_f32_32x32x16_bf16 v[96:111], v[196:199], v[148:151], v[96:111]
    v_exp_f32 v67, v67
    ds_read_b128 v[196:199], v244 offset:0
    v_mfma_f32_32x32x16_bf16 v[96:111], v[200:203], v[152:155], v[96:111]
    v_max3_f32 v248, v248, v80, v81
    v_max3_f32 v248, v248, v82, v83
    ds_read_b128 v[200:203], v245 offset:0
    s_bitcmp1_b32 s24, 10
    s_cselect_b32 m0, s32, s33
    s_cselect_b32 s14, s83, 0
    buffer_load_dwordx4 v240, s[12:15], s21 offen lds
    v_mfma_f32_32x32x16_bf16 v[96:111], v[204:207], v[156:159], v[96:111]
    v_max3_f32 v248, v248, v84, v85
    v_max3_f32 v248, v248, v86, v87
    v_max3_f32 v248, v248, v88, v89
    ds_read_b128 v[204:207], v246 offset:0
    buffer_load_dwordx4 v241, s[12:15], s21 offen offset:1024 lds
    v_mfma_f32_32x32x16_bf16 v[96:111], v[208:211], v[160:163], v[96:111]
    v_max3_f32 v248, v248, v90, v91
    v_max3_f32 v248, v248, v92, v93
    v_max3_f32 v248, v248, v94, v95
    ds_read_b128 v[208:211], v243 offset:128
    buffer_load_dwordx4 v242, s[12:15], s21 offen offset:2048 lds
    v_mfma_f32_32x32x16_bf16 v[96:111], v[212:215], v[164:167], v[96:111]
    v_fma_f32 v68, v68, s35, -v253
    v_add_f32 v249, v249, v66
    ds_read_b128 v[212:215], v244 offset:128
    s_add_u32 s21, s21, s22
    s_add_u32 s37, s21, s23
    s_min_u32 s21, s21, s37
    s_waitcnt lgkmcnt(6)
    v_mfma_f32_32x32x16_bf16 v[96:111], v[216:219], v[168:171], v[96:111]
    v_fma_f32 v69, v69, s35, -v253
    v_add_f32 v249, v249, v67
    ds_read_b128 v[216:219], v245 offset:128
    s_bitcmp1_b32 s25, 10
    s_cselect_b32 s37, s31, s30
    s_add_u32 s32, s32, s37
    v_mfma_f32_32x32x16_bf16 v[96:111], v[220:223], v[172:175], v[96:111]
    v_exp_f32 v68, v68
    ds_read_b128 v[220:223], v246 offset:128
    v_mfma_f32_32x32x16_bf16 v[96:111], v[224:227], v[176:179], v[96:111]
    v_exp_f32 v69, v69
    v_fma_f32 v70, v70, s35, -v253
    ds_read_b128 v[224:227], v243 offset:256
    v_mfma_f32_32x32x16_bf16 v[96:111], v[228:231], v[180:183], v[96:111]
    v_add_f32 v249, v249, v68
    v_fma_f32 v71, v71, s35, -v253
    ds_read_b128 v[228:231], v244 offset:256
    v_mfma_f32_32x32x16_bf16 v[96:111], v[232:235], v[184:187], v[96:111]
    v_add_f32 v249, v249, v69
    v_exp_f32 v70, v70
    ds_read_b128 v[232:235], v245 offset:256
    s_bitcmp1_b32 s25, 7
    s_cselect_b32 s44, s31, s30
    v_mfma_f32_32x32x16_bf16 v[96:111], v[236:239], v[188:191], v[96:111]
    s_waitcnt vmcnt(6)
    s_barrier
    v_exp_f32 v71, v71
    ds_read_b128 v[236:239], v246 offset:256
L_qk7:
    s_waitcnt lgkmcnt(6)
    v_mfma_f32_32x32x16_bf16 v[112:127], v[192:195], v[144:147], 0
    v_add_u32 v243, s44, v243
    v_add_u32 v244, s44, v244
    v_add_u32 v245, s44, v245
    v_add_u32 v246, s44, v246
    ds_read_b128 v[192:195], v243 offset:0
    v_mfma_f32_32x32x16_bf16 v[112:127], v[196:199], v[148:151], v[112:127]
    v_fma_f32 v72, v72, s35, -v253
    v_add_f32 v249, v249, v70
    ds_read_b128 v[196:199], v244 offset:0
    v_mfma_f32_32x32x16_bf16 v[112:127], v[200:203], v[152:155], v[112:127]
    v_max3_f32 v248, v248, v96, v97
    v_max3_f32 v248, v248, v98, v99
    ds_read_b128 v[200:203], v245 offset:0
    s_bitcmp1_b32 s24, 11
    s_cselect_b32 m0, s32, s33
    s_cselect_b32 s14, s83, 0
    buffer_load_dwordx4 v240, s[12:15], s21 offen lds
    v_mfma_f32_32x32x16_bf16 v[112:127], v[204:207], v[156:159], v[112:127]
    v_max3_f32 v248, v248, v100, v101
    v_max3_f32 v248, v248, v102, v103
    v_max3_f32 v248, v248, v104, v105
    ds_read_b128 v[204:207], v246 offset:0
    buffer_load_dwordx4 v241, s[12:15], s21 offen offset:1024 lds
    v_mfma_f32_32x32x16_bf16 v[112:127], v[208:211], v[160:163], v[112:127]
    v_max3_f32 v248, v248, v106, v107
    v_max3_f32 v248, v248, v108, v109
    v_max3_f32 v248, v248, v110, v111
    ds_read_b128 v[208:211], v243 offset:128
    buffer_load_dwordx4 v242, s[12:15], s21 offen offset:2048 lds
    v_mfma_f32_32x32x16_bf16 v[112:127], v[212:215], v[164:167], v[112:127]
    v_fma_f32 v73, v73, s35, -v253
    v_add_f32 v249, v249, v71
    ds_read_b128 v[212:215], v244 offset:128
    s_add_u32 s21, s21, s22
    s_add_u32 s37, s21, s23
    s_min_u32 s21, s21, s37
    s_waitcnt lgkmcnt(6)
    v_mfma_f32_32x32x16_bf16 v[112:127], v[216:219], v[168:171], v[112:127]
    v_exp_f32 v72, v72
    ds_read_b128 v[216:219], v245 offset:128
    s_bitcmp1_b32 s25, 11
    s_cselect_b32 s37, s31, s30
    s_add_u32 s32, s32, s37
    v_mfma_f32_32x32x16_bf16 v[112:127], v[220:223], v[172:175], v[112:127]
    v_exp_f32 v73, v73
    v_fma_f32 v74, v74, s35, -v253
    ds_read_b128 v[220:223], v246 offset:128
    v_mfma_f32_32x32x16_bf16 v[112:127], v[224:227], v[176:179], v[112:127]
    v_add_f32 v249, v249, v72
    v_fma_f32 v75, v75, s35, -v253
    ds_read_b128 v[224:227], v243 offset:256
    v_mfma_f32_32x32x16_bf16 v[112:127], v[228:231], v[180:183], v[112:127]
    v_add_f32 v249, v249, v73
    v_exp_f32 v74, v74
    ds_read_b128 v[228:231], v244 offset:256
    v_mfma_f32_32x32x16_bf16 v[112:127], v[232:235], v[184:187], v[112:127]
    v_exp_f32 v75, v75
    ds_read_b128 v[232:235], v245 offset:256
    v_mfma_f32_32x32x16_bf16 v[112:127], v[236:239], v[188:191], v[112:127]
    s_waitcnt vmcnt(6)
    s_barrier
    v_fma_f32 v76, v76, s35, -v253
    v_add_f32 v249, v249, v74
    ds_read_b128 v[236:239], v246 offset:256
L_qk8:
    s_waitcnt lgkmcnt(6)
    v_mfma_f32_32x32x16_bf16 v[128:143], v[192:195], v[144:147], v[128:143]
    v_add_u32 v243, s34, v247
    v_xor_b32 v244, 64, v243
    v_xor_b32 v245, 32, v243
    v_xor_b32 v246, 0x60, v243
    v_mfma_f32_32x32x16_bf16 v[128:143], v[196:199], v[148:151], v[128:143]
    v_fma_f32 v77, v77, s35, -v253
    v_add_f32 v249, v249, v75
    s_waitcnt lgkmcnt(0)
    v_mfma_f32_32x32x16_bf16 v[128:143], v[200:203], v[152:155], v[128:143]
    v_max3_f32 v248, v248, v112, v113
    v_max3_f32 v248, v248, v114, v115
    ds_read_b64_tr_b16 v[192:193], v243 offset:12288
    ds_read_b64_tr_b16 v[194:195], v245 offset:15360
    s_bitcmp1_b32 s24, 12
    s_cselect_b32 m0, s32, s33
    s_cselect_b32 s14, s83, 0
    buffer_load_dwordx4 v240, s[12:15], s21 offen lds
    v_mfma_f32_32x32x16_bf16 v[128:143], v[204:207], v[156:159], v[128:143]
    v_max3_f32 v248, v248, v116, v117
    v_max3_f32 v248, v248, v118, v119
    v_max3_f32 v248, v248, v120, v121
    ds_read_b64_tr_b16 v[196:197], v243 offset:18432
    ds_read_b64_tr_b16 v[198:199], v245 offset:21504
    buffer_load_dwordx4 v241, s[12:15], s21 offen offset:1024 lds
    v_mfma_f32_32x32x16_bf16 v[128:143], v[208:211], v[160:163], v[128:143]
    v_max3_f32 v248, v248, v122, v123
    v_max3_f32 v248, v248, v124, v125
    v_max3_f32 v248, v248, v126, v127
    ds_read_b64_tr_b16 v[200:201], v244 offset:12288
    ds_read_b64_tr_b16 v[202:203], v246 offset:15360
    buffer_load_dwordx4 v242, s[12:15], s21 offen offset:2048 lds
    v_mfma_f32_32x32x16_bf16 v[128:143], v[212:215], v[164:167], v[128:143]
    v_exp_f32 v76, v76
    ds_read_b64_tr_b16 v[204:205], v244 offset:18432
    ds_read_b64_tr_b16 v[206:207], v246 offset:21504
    s_add_u32 s21, s21, s22
    s_add_u32 s37, s21, s23
    s_min_u32 s21, s21, s37
    v_mfma_f32_32x32x16_bf16 v[128:143], v[216:219], v[168:171], v[128:143]
    v_exp_f32 v77, v77
    ds_read_b64_tr_b16 v[208:209], v243 offset:12416
    ds_read_b64_tr_b16 v[210:211], v245 offset:15488
    s_bitcmp1_b32 s25, 12
    s_cselect_b32 s37, s31, s30
    s_add_u32 s32, s32, s37
    v_mfma_f32_32x32x16_bf16 v[128:143], v[220:223], v[172:175], v[128:143]
    v_fma_f32 v78, v78, s35, -v253
    v_add_f32 v249, v249, v76
    v_fma_f32 v79, v79, s35, -v253
    ds_read_b64_tr_b16 v[212:213], v243 offset:18560
    ds_read_b64_tr_b16 v[214:215], v245 offset:21632
    v_mfma_f32_32x32x16_bf16 v[128:143], v[224:227], v[176:179], v[128:143]
    v_add_f32 v249, v249, v77
    ds_read_b64_tr_b16 v[216:217], v244 offset:12416
    ds_read_b64_tr_b16 v[218:219], v246 offset:15488
    v_mfma_f32_32x32x16_bf16 v[128:143], v[228:231], v[180:183], v[128:143]
    v_exp_f32 v78, v78
    v_mfma_f32_32x32x16_bf16 v[128:143], v[232:235], v[184:187], v[128:143]
    v_exp_f32 v79, v79
    v_add_f32 v249, v249, v78
    v_mfma_f32_32x32x16_bf16 v[128:143], v[236:239], v[188:191], v[128:143]
    v_add_f32 v249, v249, v79
L_pv0:
    s_setprio 2
    s_nop 10
    v_max3_f32 v248, v248, v128, v129
    v_max3_f32 v248, v248, v130, v131
    v_max3_f32 v248, v248, v132, v133
    v_max3_f32 v248, v248, v134, v135
    v_max3_f32 v248, v248, v136, v137
    v_max3_f32 v248, v248, v138, v139
    v_max3_f32 v248, v248, v140, v141
    v_max3_f32 v248, v248, v142, v143
    s_waitcnt vmcnt(6)
    s_barrier
    v_mov_b32 v250, v248
    s_nop 1
    v_permlane32_swap_b32 v250, v248
    v_max_f32 v248, v250, v248
    v_mul_f32 v248, s35, v248
    v_sub_f32 v251, v251, v248
    v_exp_f32 v251, v251
    v_sub_f32 v252, v252, v248
    v_mul_f32 v0, v251, v0
    v_mul_f32 v1, v251, v1
    v_cvt_pk_bf16_f32 v0, v0, v1
    v_mul_f32 v2, v251, v2
    v_mul_f32 v3, v251, v3
    v_cvt_pk_bf16_f32 v1, v2, v3
    v_mul_f32 v4, v251, v4
    v_mul_f32 v5, v251, v5
    v_cvt_pk_bf16_f32 v2, v4, v5
    v_mul_f32 v6, v251, v6
    v_mul_f32 v7, v251, v7
    v_cvt_pk_bf16_f32 v3, v6, v7
    v_exp_f32 v252, v252
    v_sub_f32 v253, v253, v248
    s_waitcnt lgkmcnt(12)
    v_mfma_f32_32x32x16_bf16 v[144:159], v[192:195], v[0:3], 0
    v_mul_f32 v8, v251, v8
    v_mul_f32 v9, v251, v9
    v_cvt_pk_bf16_f32 v4, v8, v9
    v_mul_f32 v10, v251, v10
    v_mul_f32 v11, v251, v11
    v_cvt_pk_bf16_f32 v5, v10, v11
    s_waitcnt lgkmcnt(8)
    v_mfma_f32_32x32x16_bf16 v[160:175], v[200:203], v[0:3], 0
    v_mul_f32 v12, v251, v12
    v_mul_f32 v13, v251, v13
    v_cvt_pk_bf16_f32 v6, v12, v13
    v_mul_f32 v14, v251, v14
    v_mul_f32 v15, v251, v15
    v_cvt_pk_bf16_f32 v7, v14, v15
    ds_read_b64_tr_b16 v[220:221], v244 offset:18560
    ds_read_b64_tr_b16 v[222:223], v246 offset:21632
    s_waitcnt lgkmcnt(6)
    v_mfma_f32_32x32x16_bf16 v[176:191], v[208:211], v[0:3], 0
    v_exp_f32 v253, v253
    s_nop 0
    v_mul_f32 v249, v253, v249
    ds_read_b64_tr_b16 v[224:225], v243 offset:12544
    ds_read_b64_tr_b16 v[226:227], v245 offset:15616
    s_bitcmp1_b32 s24, 13
    s_cselect_b32 m0, s32, s33
    s_cselect_b32 s14, s83, 0
    buffer_load_dwordx4 v240, s[12:15], s21 offen lds
    v_mfma_f32_32x32x16_bf16 v[144:159], v[196:199], v[4:7], v[144:159]
    v_mul_f32 v16, v251, v16
    v_mul_f32 v17, v251, v17
    v_cvt_pk_bf16_f32 v16, v16, v17
    v_mul_f32 v18, v251, v18
    ds_read_b64_tr_b16 v[228:229], v243 offset:18688
    ds_read_b64_tr_b16 v[230:231], v245 offset:21760
    buffer_load_dwordx4 v241, s[12:15], s21 offen offset:1024 lds
    v_mfma_f32_32x32x16_bf16 v[160:175], v[204:207], v[4:7], v[160:175]
    v_mul_f32 v19, v251, v19
    v_cvt_pk_bf16_f32 v17, v18, v19
    v_mul_f32 v20, v251, v20
    v_mul_f32 v21, v251, v21
    v_cvt_pk_bf16_f32 v18, v20, v21
    ds_read_b64_tr_b16 v[8:9], v244 offset:12544
    ds_read_b64_tr_b16 v[10:11], v246 offset:15616
    buffer_load_dwordx4 v242, s[12:15], s21 offen offset:2048 lds
    s_waitcnt lgkmcnt(10)
    v_mfma_f32_32x32x16_bf16 v[176:191], v[212:215], v[4:7], v[176:191]
    v_mul_f32 v22, v251, v22
    v_mul_f32 v23, v251, v23
    v_cvt_pk_bf16_f32 v19, v22, v23
    v_mul_f32 v24, v251, v24
    v_mul_f32 v25, v251, v25
    ds_read_b64_tr_b16 v[12:13], v244 offset:18688
    ds_read_b64_tr_b16 v[14:15], v246 offset:21760
    s_bitcmp1_b32 s25, 9
    s_cselect_b32 s44, s31, s30
    s_add_u32 s21, s21, s22
    s_add_u32 s37, s21, s23
    s_min_u32 s21, s21, s37
    s_waitcnt lgkmcnt(10)
    v_mfma_f32_32x32x16_bf16 v[192:207], v[216:219], v[0:3], 0
    v_cvt_pk_bf16_f32 v20, v24, v25
    v_mul_f32 v26, v251, v26
    v_mul_f32 v27, v251, v27
    v_cvt_pk_bf16_f32 v21, v26, v27
    s_bitcmp1_b32 s25, 13
    s_cselect_b32 s37, s31, s30
    s_add_u32 s32, s32, s37
    s_waitcnt lgkmcnt(8)
    v_mfma_f32_32x32x16_bf16 v[192:207], v[220:223], v[4:7], v[192:207]
    v_add_u32 v243, s44, v243
    v_add_u32 v244, s44, v244
    v_add_u32 v245, s44, v245
    v_add_u32 v246, s44, v246
    v_mul_f32 v28, v251, v28
    s_waitcnt lgkmcnt(6)
    v_mfma_f32_32x32x16_bf16 v[208:223], v[224:227], v[0:3], 0
    v_mul_f32 v29, v251, v29
    v_cvt_pk_bf16_f32 v22, v28, v29
    v_mul_f32 v30, v251, v30
    v_mul_f32 v31, v251, v31
    v_cvt_pk_bf16_f32 v23, v30, v31
    ds_read_b64_tr_b16 v[24:25], v243 offset:12288
    ds_read_b64_tr_b16 v[26:27], v245 offset:15360
    s_waitcnt lgkmcnt(6)
    v_mfma_f32_32x32x16_bf16 v[208:223], v[228:231], v[4:7], v[208:223]
    v_fma_f32 v80, v80, s35, -v248
    v_fma_f32 v81, v81, s35, -v248
    v_exp_f32 v80, v80
    ds_read_b64_tr_b16 v[28:29], v243 offset:18432
    ds_read_b64_tr_b16 v[30:31], v245 offset:21504
    s_waitcnt lgkmcnt(6)
    v_mfma_f32_32x32x16_bf16 v[224:239], v[8:11], v[0:3], 0
    v_exp_f32 v81, v81
    v_fma_f32 v82, v82, s35, -v248
    v_add_f32 v249, v249, v80
    v_fma_f32 v83, v83, s35, -v248
    ds_read_b64_tr_b16 v[8:9], v244 offset:12288
    ds_read_b64_tr_b16 v[10:11], v246 offset:15360
    ds_read_b64_tr_b16 v[0:1], v244 offset:18432
    ds_read_b64_tr_b16 v[2:3], v246 offset:21504
    s_waitcnt lgkmcnt(8)
    v_mfma_f32_32x32x16_bf16 v[224:239], v[12:15], v[4:7], v[224:239]
    s_waitcnt vmcnt(6)
    s_barrier
    v_add_f32 v249, v249, v81
    v_cvt_pk_bf16_f32 v80, v80, v81
    v_exp_f32 v82, v82
    ds_read_b64_tr_b16 v[12:13], v243 offset:12416
    ds_read_b64_tr_b16 v[14:15], v245 offset:15488
    ds_read_b64_tr_b16 v[4:5], v243 offset:18560
    ds_read_b64_tr_b16 v[6:7], v245 offset:21632
    s_setprio 0
L_pv1:
    s_bitcmp0_b32 s36, 1
    s_cbranch_scc1 L_pv1_inv
    s_waitcnt lgkmcnt(8)
    v_mfma_f32_32x32x16_bf16 v[144:159], v[24:27], v[16:19], v[144:159]
    v_exp_f32 v83, v83
    v_fma_f32 v84, v84, s35, -v248
    v_add_f32 v249, v249, v82
    v_fma_f32 v85, v85, s35, -v248
    ds_read_b64_tr_b16 v[24:25], v244 offset:12416
    ds_read_b64_tr_b16 v[26:27], v246 offset:15488
    v_mfma_f32_32x32x16_bf16 v[144:159], v[28:31], v[20:23], v[144:159]
    v_add_f32 v249, v249, v83
    v_cvt_pk_bf16_f32 v81, v82, v83
    v_exp_f32 v84, v84
    ds_read_b64_tr_b16 v[28:29], v244 offset:18560
    ds_read_b64_tr_b16 v[30:31], v246 offset:21632
    s_waitcnt lgkmcnt(8)
    v_mfma_f32_32x32x16_bf16 v[160:175], v[8:11], v[16:19], v[160:175]
    v_exp_f32 v85, v85
    v_fma_f32 v86, v86, s35, -v248
    v_add_f32 v249, v249, v84
    v_mul_f32 v32, v252, v32
    ds_read_b64_tr_b16 v[8:9], v243 offset:12544
    ds_read_b64_tr_b16 v[10:11], v245 offset:15616
    s_bitcmp1_b32 s24, 14
    s_cselect_b32 m0, s32, s33
    s_cselect_b32 s14, s83, 0
    buffer_load_dwordx4 v240, s[12:15], s21 offen lds
    v_mfma_f32_32x32x16_bf16 v[160:175], v[0:3], v[20:23], v[160:175]
    v_mul_f32 v33, v252, v33
    v_cvt_pk_bf16_f32 v32, v32, v33
    v_mul_f32 v34, v252, v34
    v_mul_f32 v35, v252, v35
    v_cvt_pk_bf16_f32 v33, v34, v35
    ds_read_b64_tr_b16 v[0:1], v243 offset:18688
    ds_read_b64_tr_b16 v[2:3], v245 offset:21760
    buffer_load_dwordx4 v241, s[12:15], s21 offen offset:1024 lds
    s_waitcnt lgkmcnt(8)
    v_mfma_f32_32x32x16_bf16 v[176:191], v[12:15], v[16:19], v[176:191]
    v_mul_f32 v36, v252, v36
    v_mul_f32 v37, v252, v37
    v_cvt_pk_bf16_f32 v34, v36, v37
    v_mul_f32 v38, v252, v38
    v_mul_f32 v39, v252, v39
    ds_read_b64_tr_b16 v[12:13], v244 offset:12544
    ds_read_b64_tr_b16 v[14:15], v246 offset:15616
    s_bitcmp1_b32 s25, 10
    s_cselect_b32 s44, s31, s30
    buffer_load_dwordx4 v242, s[12:15], s21 offen offset:2048 lds
    v_mfma_f32_32x32x16_bf16 v[176:191], v[4:7], v[20:23], v[176:191]
    v_cvt_pk_bf16_f32 v35, v38, v39
    v_mul_f32 v40, v252, v40
    v_mul_f32 v41, v252, v41
    v_cvt_pk_bf16_f32 v36, v40, v41
    ds_read_b64_tr_b16 v[4:5], v244 offset:18688
    ds_read_b64_tr_b16 v[6:7], v246 offset:21760
    s_add_u32 s21, s21, s22
    s_add_u32 s37, s21, s23
    s_min_u32 s21, s21, s37
    s_waitcnt lgkmcnt(8)
    v_mfma_f32_32x32x16_bf16 v[192:207], v[24:27], v[16:19], v[192:207]
    v_add_u32 v243, s44, v243
    v_add_u32 v244, s44, v244
    v_add_u32 v245, s44, v245
    v_add_u32 v246, s44, v246
    v_mul_f32 v42, v252, v42
    ds_read_b64_tr_b16 v[24:25], v243 offset:12288
    ds_read_b64_tr_b16 v[26:27], v245 offset:15360
    s_bitcmp1_b32 s25, 14
    s_cselect_b32 s37, s31, s30
    s_add_u32 s32, s32, s37
    v_mfma_f32_32x32x16_bf16 v[192:207], v[28:31], v[20:23], v[192:207]
    v_mul_f32 v43, v252, v43
    v_cvt_pk_bf16_f32 v37, v42, v43
    v_mul_f32 v44, v252, v44
    v_mul_f32 v45, v252, v45
    v_cvt_pk_bf16_f32 v38, v44, v45
    ds_read_b64_tr_b16 v[28:29], v243 offset:18432
    ds_read_b64_tr_b16 v[30:31], v245 offset:21504
    s_waitcnt lgkmcnt(8)
    v_mfma_f32_32x32x16_bf16 v[208:223], v[8:11], v[16:19], v[208:223]
    v_mul_f32 v46, v252, v46
    v_mul_f32 v47, v252, v47
    v_cvt_pk_bf16_f32 v39, v46, v47
    v_fma_f32 v87, v87, s35, -v248
    ds_read_b64_tr_b16 v[8:9], v244 offset:12288
    ds_read_b64_tr_b16 v[10:11], v246 offset:15360
    v_mfma_f32_32x32x16_bf16 v[208:223], v[0:3], v[20:23], v[208:223]
    v_add_f32 v249, v249, v85
    v_cvt_pk_bf16_f32 v82, v84, v85
    v_exp_f32 v86, v86
    ds_read_b64_tr_b16 v[0:1], v244 offset:18432
    ds_read_b64_tr_b16 v[2:3], v246 offset:21504
    s_waitcnt lgkmcnt(8)
    v_mfma_f32_32x32x16_bf16 v[224:239], v[12:15], v[16:19], v[224:239]
    v_exp_f32 v87, v87
    v_fma_f32 v88, v88, s35, -v248
    v_add_f32 v249, v249, v86
    v_fma_f32 v89, v89, s35, -v248
    ds_read_b64_tr_b16 v[12:13], v243 offset:12416
    ds_read_b64_tr_b16 v[14:15], v245 offset:15488
    v_mfma_f32_32x32x16_bf16 v[224:239], v[4:7], v[20:23], v[224:239]
    s_waitcnt vmcnt(6)
    s_barrier
    v_add_f32 v249, v249, v87
    v_cvt_pk_bf16_f32 v83, v86, v87
    v_exp_f32 v88, v88
    ds_read_b64_tr_b16 v[4:5], v243 offset:18560
    ds_read_b64_tr_b16 v[6:7], v245 offset:21632
L_pv2:
    s_bitcmp0_b32 s36, 2
    s_cbranch_scc1 L_pv2_inv
    s_waitcnt lgkmcnt(8)
    v_mfma_f32_32x32x16_bf16 v[144:159], v[24:27], v[32:35], v[144:159]
    v_exp_f32 v89, v89
    v_fma_f32 v90, v90, s35, -v248
    v_add_f32 v249, v249, v88
    v_fma_f32 v91, v91, s35, -v248
    ds_read_b64_tr_b16 v[24:25], v244 offset:12416
    ds_read_b64_tr_b16 v[26:27], v246 offset:15488
    v_mfma_f32_32x32x16_bf16 v[144:159], v[28:31], v[36:39], v[144:159]
    v_add_f32 v249, v249, v89
    v_cvt_pk_bf16_f32 v84, v88, v89
    v_exp_f32 v90, v90
    ds_read_b64_tr_b16 v[28:29], v244 offset:18560
    ds_read_b64_tr_b16 v[30:31], v246 offset:21632
    s_waitcnt lgkmcnt(8)
    v_mfma_f32_32x32x16_bf16 v[160:175], v[8:11], v[32:35], v[160:175]
    v_exp_f32 v91, v91
    v_fma_f32 v92, v92, s35, -v248
    v_mul_f32 v48, v252, v48
    v_mul_f32 v49, v252, v49
    ds_read_b64_tr_b16 v[8:9], v243 offset:12544
    ds_read_b64_tr_b16 v[10:11], v245 offset:15616
    s_bitcmp1_b32 s24, 15
    s_cselect_b32 m0, s32, s33
    s_cselect_b32 s14, s83, 0
    buffer_load_dwordx4 v240, s[12:15], s21 offen lds
    v_mfma_f32_32x32x16_bf16 v[160:175], v[0:3], v[36:39], v[160:175]
    v_cvt_pk_bf16_f32 v48, v48, v49
    v_mul_f32 v50, v252, v50
    v_mul_f32 v51, v252, v51
    v_cvt_pk_bf16_f32 v49, v50, v51
    v_mul_f32 v52, v252, v52
    ds_read_b64_tr_b16 v[0:1], v243 offset:18688
    ds_read_b64_tr_b16 v[2:3], v245 offset:21760
    buffer_load_dwordx4 v241, s[12:15], s21 offen offset:1024 lds
    s_waitcnt lgkmcnt(8)
    v_mfma_f32_32x32x16_bf16 v[176:191], v[12:15], v[32:35], v[176:191]
    v_mul_f32 v53, v252, v53
    v_cvt_pk_bf16_f32 v50, v52, v53
    v_mul_f32 v54, v252, v54
    v_mul_f32 v55, v252, v55
    v_cvt_pk_bf16_f32 v51, v54, v55
    ds_read_b64_tr_b16 v[12:13], v244 offset:12544
    ds_read_b64_tr_b16 v[14:15], v246 offset:15616
    s_bitcmp1_b32 s25, 11
    s_cselect_b32 s44, s31, s30
    buffer_load_dwordx4 v242, s[12:15], s21 offen offset:2048 lds
    v_mfma_f32_32x32x16_bf16 v[176:191], v[4:7], v[36:39], v[176:191]
    v_mul_f32 v56, v252, v56
    v_mul_f32 v57, v252, v57
    v_cvt_pk_bf16_f32 v52, v56, v57
    v_mul_f32 v58, v252, v58
    ds_read_b64_tr_b16 v[4:5], v244 offset:18688
    ds_read_b64_tr_b16 v[6:7], v246 offset:21760
    s_add_u32 s21, s21, s22
    s_add_u32 s37, s21, s23
    s_min_u32 s21, s21, s37
    s_waitcnt lgkmcnt(8)
    v_mfma_f32_32x32x16_bf16 v[192:207], v[24:27], v[32:35], v[192:207]
    v_add_u32 v243, s44, v243
    v_add_u32 v244, s44, v244
    v_add_u32 v245, s44, v245
    v_add_u32 v246, s44, v246
    v_mul_f32 v59, v252, v59
    ds_read_b64_tr_b16 v[24:25], v243 offset:12288
    ds_read_b64_tr_b16 v[26:27], v245 offset:15360
    s_bitcmp1_b32 s25, 15
    s_cselect_b32 s37, s31, s30
    s_add_u32 s32, s32, s37
    v_mfma_f32_32x32x16_bf16 v[192:207], v[28:31], v[36:39], v[192:207]
    v_cvt_pk_bf16_f32 v53, v58, v59
    v_mul_f32 v60, v252, v60
    v_mul_f32 v61, v252, v61
    v_cvt_pk_bf16_f32 v54, v60, v61
    v_mul_f32 v62, v252, v62
    ds_read_b64_tr_b16 v[28:29], v243 offset:18432
    ds_read_b64_tr_b16 v[30:31], v245 offset:21504
    s_waitcnt lgkmcnt(8)
    v_mfma_f32_32x32x16_bf16 v[208:223], v[8:11], v[32:35], v[208:223]
    v_mul_f32 v63, v252, v63
    v_cvt_pk_bf16_f32 v55, v62, v63
    v_add_f32 v249, v249, v90
    v_fma_f32 v93, v93, s35, -v248
    ds_read_b64_tr_b16 v[8:9], v244 offset:12288
    ds_read_b64_tr_b16 v[10:11], v246 offset:15360
    v_mfma_f32_32x32x16_bf16 v[208:223], v[0:3], v[36:39], v[208:223]
    v_add_f32 v249, v249, v91
    v_cvt_pk_bf16_f32 v85, v90, v91
    v_exp_f32 v92, v92
    ds_read_b64_tr_b16 v[0:1], v244 offset:18432
    ds_read_b64_tr_b16 v[2:3], v246 offset:21504
    s_waitcnt lgkmcnt(8)
    v_mfma_f32_32x32x16_bf16 v[224:239], v[12:15], v[32:35], v[224:239]
    v_exp_f32 v93, v93
    v_fma_f32 v94, v94, s35, -v248
    v_add_f32 v249, v249, v92
    v_fma_f32 v95, v95, s35, -v248
    ds_read_b64_tr_b16 v[12:13], v243 offset:12416
    ds_read_b64_tr_b16 v[14:15], v245 offset:15488
    v_mfma_f32_32x32x16_bf16 v[224:239], v[4:7], v[36:39], v[224:239]
    s_waitcnt vmcnt(6)
    s_barrier
    v_add_f32 v249, v249, v93
    v_cvt_pk_bf16_f32 v86, v92, v93
    v_exp_f32 v94, v94
    ds_read_b64_tr_b16 v[4:5], v243 offset:18560
    ds_read_b64_tr_b16 v[6:7], v245 offset:21632
L_pv3:
    s_bitcmp0_b32 s36, 3
    s_cbranch_scc1 L_pv3_inv
    s_waitcnt lgkmcnt(8)
    v_mfma_f32_32x32x16_bf16 v[144:159], v[24:27], v[48:51], v[144:159]
    v_exp_f32 v95, v95
    v_add_f32 v249, v249, v94
    v_add_f32 v249, v249, v95
    v_cvt_pk_bf16_f32 v87, v94, v95
    ds_read_b64_tr_b16 v[24:25], v244 offset:12416
    ds_read_b64_tr_b16 v[26:27], v246 offset:15488
    v_mfma_f32_32x32x16_bf16 v[144:159], v[28:31], v[52:55], v[144:159]
    v_fma_f32 v96, v96, s35, -v248
    v_fma_f32 v97, v97, s35, -v248
    v_exp_f32 v96, v96
    ds_read_b64_tr_b16 v[28:29], v244 offset:18560
    ds_read_b64_tr_b16 v[30:31], v246 offset:21632
    s_waitcnt lgkmcnt(8)
    v_mfma_f32_32x32x16_bf16 v[160:175], v[8:11], v[48:51], v[160:175]
    v_exp_f32 v97, v97
    v_mul_f32 v64, v253, v64
    v_mul_f32 v65, v253, v65
    v_cvt_pk_bf16_f32 v64, v64, v65
    ds_read_b64_tr_b16 v[8:9], v243 offset:12544
    ds_read_b64_tr_b16 v[10:11], v245 offset:15616
    s_bitcmp1_b32 s24, 16
    s_cselect_b32 m0, s32, s33
    s_cselect_b32 s14, s83, 0
    buffer_load_dwordx4 v240, s[12:15], s21 offen lds
    v_mfma_f32_32x32x16_bf16 v[160:175], v[0:3], v[52:55], v[160:175]
    v_mul_f32 v66, v253, v66
    v_mul_f32 v67, v253, v67
    v_cvt_pk_bf16_f32 v65, v66, v67
    v_mul_f32 v68, v253, v68
    v_mul_f32 v69, v253, v69
    ds_read_b64_tr_b16 v[0:1], v243 offset:18688
    ds_read_b64_tr_b16 v[2:3], v245 offset:21760
    buffer_load_dwordx4 v241, s[12:15], s21 offen offset:1024 lds
    s_waitcnt lgkmcnt(8)
    v_mfma_f32_32x32x16_bf16 v[176:191], v[12:15], v[48:51], v[176:191]
    v_cvt_pk_bf16_f32 v66, v68, v69
    v_mul_f32 v70, v253, v70
    v_mul_f32 v71, v253, v71
    v_cvt_pk_bf16_f32 v67, v70, v71
    v_mul_f32 v72, v253, v72
    ds_read_b64_tr_b16 v[12:13], v244 offset:12544
    ds_read_b64_tr_b16 v[14:15], v246 offset:15616
    s_bitcmp1_b32 s25, 12
    s_cselect_b32 s44, s31, s30
    buffer_load_dwordx4 v242, s[12:15], s21 offen offset:2048 lds
    v_mfma_f32_32x32x16_bf16 v[176:191], v[4:7], v[52:55], v[176:191]
    v_mul_f32 v73, v253, v73
    v_cvt_pk_bf16_f32 v68, v72, v73
    v_mul_f32 v74, v253, v74
    v_mul_f32 v75, v253, v75
    ds_read_b64_tr_b16 v[4:5], v244 offset:18688
    ds_read_b64_tr_b16 v[6:7], v246 offset:21760
    s_add_u32 s21, s21, s22
    s_add_u32 s37, s21, s23
    s_min_u32 s21, s21, s37
    s_waitcnt lgkmcnt(8)
    v_mfma_f32_32x32x16_bf16 v[192:207], v[24:27], v[48:51], v[192:207]
    v_add_u32 v243, s44, v243
    v_add_u32 v244, s44, v244
    v_add_u32 v245, s44, v245
    v_add_u32 v246, s44, v246
    v_cvt_pk_bf16_f32 v69, v74, v75
    ds_read_b64_tr_b16 v[24:25], v243 offset:12288
    ds_read_b64_tr_b16 v[26:27], v245 offset:15360
    s_bitcmp1_b32 s25, 16
    s_cselect_b32 s37, s31, s30
    s_add_u32 s32, s32, s37
    v_mfma_f32_32x32x16_bf16 v[192:207], v[28:31], v[52:55], v[192:207]
    v_mul_f32 v76, v253, v76
    v_mul_f32 v77, v253, v77
    v_cvt_pk_bf16_f32 v70, v76, v77
    v_mul_f32 v78, v253, v78
    v_mul_f32 v79, v253, v79
    ds_read_b64_tr_b16 v[28:29], v243 offset:18432
    ds_read_b64_tr_b16 v[30:31], v245 offset:21504
    s_waitcnt lgkmcnt(8)
    v_mfma_f32_32x32x16_bf16 v[208:223], v[8:11], v[48:51], v[208:223]
    v_cvt_pk_bf16_f32 v71, v78, v79
    v_fma_f32 v98, v98, s35, -v248
    v_add_f32 v249, v249, v96
    v_fma_f32 v99, v99, s35, -v248
    ds_read_b64_tr_b16 v[8:9], v244 offset:12288
    ds_read_b64_tr_b16 v[10:11], v246 offset:15360
    v_mfma_f32_32x32x16_bf16 v[208:223], v[0:3], v[52:55], v[208:223]
    v_add_f32 v249, v249, v97
    v_cvt_pk_bf16_f32 v96, v96, v97
    v_exp_f32 v98, v98
    ds_read_b64_tr_b16 v[0:1], v244 offset:18432
    ds_read_b64_tr_b16 v[2:3], v246 offset:21504
    s_waitcnt lgkmcnt(8)
    v_mfma_f32_32x32x16_bf16 v[224:239], v[12:15], v[48:51], v[224:239]
    v_exp_f32 v99, v99
    v_fma_f32 v100, v100, s35, -v248
    v_add_f32 v249, v249, v98
    v_fma_f32 v101, v101, s35, -v248
    ds_read_b64_tr_b16 v[12:13], v243 offset:12416
    ds_read_b64_tr_b16 v[14:15], v245 offset:15488
    v_mfma_f32_32x32x16_bf16 v[224:239], v[4:7], v[52:55], v[224:239]
    s_waitcnt vmcnt(6)
    s_barrier
    v_add_f32 v249, v249, v99
    v_cvt_pk_bf16_f32 v97, v98, v99
    v_exp_f32 v100, v100
    ds_read_b64_tr_b16 v[4:5], v243 offset:18560
    ds_read_b64_tr_b16 v[6:7], v245 offset:21632
L_pv4:
    s_bitcmp0_b32 s36, 4
    s_cbranch_scc1 L_pv4_inv
    s_waitcnt lgkmcnt(8)
    v_mfma_f32_32x32x16_bf16 v[144:159], v[24:27], v[64:67], v[144:159]
    v_exp_f32 v101, v101
    v_fma_f32 v102, v102, s35, -v248
    v_add_f32 v249, v249, v100
    v_fma_f32 v103, v103, s35, -v248
    ds_read_b64_tr_b16 v[24:25], v244 offset:12416
    ds_read_b64_tr_b16 v[26:27], v246 offset:15488
    v_mfma_f32_32x32x16_bf16 v[144:159], v[28:31], v[68:71], v[144:159]
    v_add_f32 v249, v249, v101
    v_cvt_pk_bf16_f32 v98, v100, v101
    v_exp_f32 v102, v102
    ds_read_b64_tr_b16 v[28:29], v244 offset:18560
    ds_read_b64_tr_b16 v[30:31], v246 offset:21632
    s_waitcnt lgkmcnt(8)
    v_mfma_f32_32x32x16_bf16 v[160:175], v[8:11], v[64:67], v[160:175]
    v_exp_f32 v103, v103
    v_fma_f32 v104, v104, s35, -v248
    v_add_f32 v249, v249, v102
    v_fma_f32 v105, v105, s35, -v248
    ds_read_b64_tr_b16 v[8:9], v243 offset:12544
    ds_read_b64_tr_b16 v[10:11], v245 offset:15616
    s_bitcmp1_b32 s24, 17
    s_cselect_b32 m0, s32, s33
    s_cselect_b32 s14, s83, 0
    buffer_load_dwordx4 v240, s[12:15], s21 offen lds
    v_mfma_f32_32x32x16_bf16 v[160:175], v[0:3], v[68:71], v[160:175]
    v_add_f32 v249, v249, v103
    v_cvt_pk_bf16_f32 v99, v102, v103
    v_exp_f32 v104, v104
    ds_read_b64_tr_b16 v[0:1], v243 offset:18688
    ds_read_b64_tr_b16 v[2:3], v245 offset:21760
    buffer_load_dwordx4 v241, s[12:15], s21 offen offset:1024 lds
    s_waitcnt lgkmcnt(8)
    v_mfma_f32_32x32x16_bf16 v[176:191], v[12:15], v[64:67], v[176:191]
    v_exp_f32 v105, v105
    v_fma_f32 v106, v106, s35, -v248
    v_add_f32 v249, v249, v104
    v_fma_f32 v107, v107, s35, -v248
    ds_read_b64_tr_b16 v[12:13], v244 offset:12544
    ds_read_b64_tr_b16 v[14:15], v246 offset:15616
    s_bitcmp1_b32 s25, 13
    s_cselect_b32 s44, s31, s30
    buffer_load_dwordx4 v242, s[12:15], s21 offen offset:2048 lds
    v_mfma_f32_32x32x16_bf16 v[176:191], v[4:7], v[68:71], v[176:191]
    v_add_f32 v249, v249, v105
    v_cvt_pk_bf16_f32 v100, v104, v105
    v_exp_f32 v106, v106
    ds_read_b64_tr_b16 v[4:5], v244 offset:18688
    ds_read_b64_tr_b16 v[6:7], v246 offset:21760
    s_add_u32 s21, s21, s22
    s_add_u32 s37, s21, s23
    s_min_u32 s21, s21, s37
    s_waitcnt lgkmcnt(8)
    v_mfma_f32_32x32x16_bf16 v[192:207], v[24:27], v[64:67], v[192:207]
    v_add_u32 v243, s44, v243
    v_add_u32 v244, s44, v244
    v_add_u32 v245, s44, v245
    v_add_u32 v246, s44, v246
    ds_read_b64_tr_b16 v[24:25], v243 offset:12288
    ds_read_b64_tr_b16 v[26:27], v245 offset:15360
    s_bitcmp1_b32 s25, 17
    s_cselect_b32 s37, s31, s30
    s_add_u32 s32, s32, s37
    v_mfma_f32_32x32x16_bf16 v[192:207], v[28:31], v[68:71], v[192:207]
    v_exp_f32 v107, v107
    v_fma_f32 v108, v108, s35, -v248
    v_add_f32 v249, v249, v106
    v_fma_f32 v109, v109, s35, -v248
    ds_read_b64_tr_b16 v[28:29], v243 offset:18432
    ds_read_b64_tr_b16 v[30:31], v245 offset:21504
    s_waitcnt lgkmcnt(8)
    v_mfma_f32_32x32x16_bf16 v[208:223], v[8:11], v[64:67], v[208:223]
    v_add_f32 v249, v249, v107
    v_cvt_pk_bf16_f32 v101, v106, v107
    v_exp_f32 v108, v108
    ds_read_b64_tr_b16 v[8:9], v244 offset:12288
    ds_read_b64_tr_b16 v[10:11], v246 offset:15360
    v_mfma_f32_32x32x16_bf16 v[208:223], v[0:3], v[68:71], v[208:223]
    v_exp_f32 v109, v109
    v_fma_f32 v110, v110, s35, -v248
    v_add_f32 v249, v249, v108
    v_fma_f32 v111, v111, s35, -v248
    ds_read_b64_tr_b16 v[0:1], v244 offset:18432
    ds_read_b64_tr_b16 v[2:3], v246 offset:21504
    s_waitcnt lgkmcnt(8)
    v_mfma_f32_32x32x16_bf16 v[224:239], v[12:15], v[64:67], v[224:239]
    v_add_f32 v249, v249, v109
    v_cvt_pk_bf16_f32 v102, v108, v109
    v_exp_f32 v110, v110
    ds_read_b64_tr_b16 v[12:13], v243 offset:12416
    ds_read_b64_tr_b16 v[14:15], v245 offset:15488
    v_mfma_f32_32x32x16_bf16 v[224:239], v[4:7], v[68:71], v[224:239]
    s_waitcnt vmcnt(6)
    s_barrier
    v_exp_f32 v111, v111
    v_add_f32 v249, v249, v110
    v_add_f32 v249, v249, v111
    v_cvt_pk_bf16_f32 v103, v110, v111
    ds_read_b64_tr_b16 v[4:5], v243 offset:18560
    ds_read_b64_tr_b16 v[6:7], v245 offset:21632
L_pv5:
    s_cbranch_vccnz L_pv5b
    s_waitcnt lgkmcnt(8)
    v_mfma_f32_32x32x16_bf16 v[144:159], v[24:27], v[80:83], v[144:159]
    v_fma_f32 v112, v112, s35, -v248
    v_fma_f32 v113, v113, s35, -v248
    v_exp_f32 v112, v112
    ds_read_b64_tr_b16 v[24:25], v244 offset:12416
    ds_read_b64_tr_b16 v[26:27], v246 offset:15488
    v_mfma_f32_32x32x16_bf16 v[144:159], v[28:31], v[84:87], v[144:159]
    v_exp_f32 v113, v113
    v_fma_f32 v114, v114, s35, -v248
    v_add_f32 v249, v249, v112
    v_fma_f32 v115, v115, s35, -v248
    ds_read_b64_tr_b16 v[28:29], v244 offset:18560
    ds_read_b64_tr_b16 v[30:31], v246 offset:21632
    s_waitcnt lgkmcnt(8)
    v_mfma_f32_32x32x16_bf16 v[160:175], v[8:11], v[80:83], v[160:175]
    v_add_f32 v249, v249, v113
    v_cvt_pk_bf16_f32 v112, v112, v113
    v_exp_f32 v114, v114
    ds_read_b64_tr_b16 v[8:9], v243 offset:12544
    ds_read_b64_tr_b16 v[10:11], v245 offset:15616
    v_mfma_f32_32x32x16_bf16 v[160:175], v[0:3], v[84:87], v[160:175]
    v_exp_f32 v115, v115
    v_fma_f32 v116, v116, s35, -v248
    v_add_f32 v249, v249, v114
    v_fma_f32 v117, v117, s35, -v248
    ds_read_b64_tr_b16 v[0:1], v243 offset:18688
    ds_read_b64_tr_b16 v[2:3], v245 offset:21760
    s_waitcnt lgkmcnt(8)
    v_mfma_f32_32x32x16_bf16 v[176:191], v[12:15], v[80:83], v[176:191]
    v_add_f32 v249, v249, v115
    v_cvt_pk_bf16_f32 v113, v114, v115
    v_exp_f32 v116, v116
    ds_read_b64_tr_b16 v[12:13], v244 offset:12544
    ds_read_b64_tr_b16 v[14:15], v246 offset:15616
    s_bitcmp1_b32 s25, 14
    s_cselect_b32 s44, s31, s30
    v_mfma_f32_32x32x16_bf16 v[176:191], v[4:7], v[84:87], v[176:191]
    v_exp_f32 v117, v117
    v_fma_f32 v118, v118, s35, -v248
    v_add_f32 v249, v249, v116
    v_fma_f32 v119, v119, s35, -v248
    ds_read_b64_tr_b16 v[4:5], v244 offset:18688
    ds_read_b64_tr_b16 v[6:7], v246 offset:21760
    s_waitcnt lgkmcnt(8)
    v_mfma_f32_32x32x16_bf16 v[192:207], v[24:27], v[80:83], v[192:207]
    v_add_u32 v243, s44, v243
    v_add_u32 v244, s44, v244
    v_add_u32 v245, s44, v245
    v_add_u32 v246, s44, v246
    v_add_f32 v249, v249, v117
    ds_read_b64_tr_b16 v[24:25], v243 offset:12288
    ds_read_b64_tr_b16 v[26:27], v245 offset:15360
    v_mfma_f32_32x32x16_bf16 v[192:207], v[28:31], v[84:87], v[192:207]
    v_cvt_pk_bf16_f32 v114, v116, v117
    v_exp_f32 v118, v118
    v_exp_f32 v119, v119
    ds_read_b64_tr_b16 v[28:29], v243 offset:18432
    ds_read_b64_tr_b16 v[30:31], v245 offset:21504
    s_waitcnt lgkmcnt(8)
    v_mfma_f32_32x32x16_bf16 v[208:223], v[8:11], v[80:83], v[208:223]
    v_fma_f32 v120, v120, s35, -v248
    v_add_f32 v249, v249, v118
    v_fma_f32 v121, v121, s35, -v248
    v_add_f32 v249, v249, v119
    ds_read_b64_tr_b16 v[8:9], v244 offset:12288
    ds_read_b64_tr_b16 v[10:11], v246 offset:15360
    v_mfma_f32_32x32x16_bf16 v[208:223], v[0:3], v[84:87], v[208:223]
    v_cvt_pk_bf16_f32 v115, v118, v119
    v_exp_f32 v120, v120
    v_exp_f32 v121, v121
    ds_read_b64_tr_b16 v[0:1], v244 offset:18432
    ds_read_b64_tr_b16 v[2:3], v246 offset:21504
    s_waitcnt lgkmcnt(8)
    v_mfma_f32_32x32x16_bf16 v[224:239], v[12:15], v[80:83], v[224:239]
    v_fma_f32 v122, v122, s35, -v248
    v_add_f32 v249, v249, v120
    v_fma_f32 v123, v123, s35, -v248
    v_add_f32 v249, v249, v121
    v_cvt_pk_bf16_f32 v116, v120, v121
    ds_read_b64_tr_b16 v[12:13], v243 offset:12416
    ds_read_b64_tr_b16 v[14:15], v245 offset:15488
    v_mfma_f32_32x32x16_bf16 v[224:239], v[4:7], v[84:87], v[224:239]
    s_barrier
    v_exp_f32 v122, v122
    v_exp_f32 v123, v123
    ds_read_b64_tr_b16 v[4:5], v243 offset:18560
    ds_read_b64_tr_b16 v[6:7], v245 offset:21632
L_pv6:
    s_waitcnt lgkmcnt(8)
    v_mfma_f32_32x32x16_bf16 v[144:159], v[24:27], v[96:99], v[144:159]
    v_fma_f32 v124, v124, s35, -v248
    v_add_f32 v249, v249, v122
    v_fma_f32 v125, v125, s35, -v248
    v_add_f32 v249, v249, v123
    v_cvt_pk_bf16_f32 v117, v122, v123
    ds_read_b64_tr_b16 v[24:25], v244 offset:12416
    ds_read_b64_tr_b16 v[26:27], v246 offset:15488
    v_mfma_f32_32x32x16_bf16 v[144:159], v[28:31], v[100:103], v[144:159]
    v_exp_f32 v124, v124
    v_exp_f32 v125, v125
    v_fma_f32 v126, v126, s35, -v248
    ds_read_b64_tr_b16 v[28:29], v244 offset:18560
    ds_read_b64_tr_b16 v[30:31], v246 offset:21632
    s_waitcnt lgkmcnt(8)
    v_mfma_f32_32x32x16_bf16 v[160:175], v[8:11], v[96:99], v[160:175]
    v_add_f32 v249, v249, v124
    v_fma_f32 v127, v127, s35, -v248
    v_add_f32 v249, v249, v125
    v_cvt_pk_bf16_f32 v118, v124, v125
    ds_read_b64_tr_b16 v[8:9], v243 offset:12544
    ds_read_b64_tr_b16 v[10:11], v245 offset:15616
    v_mfma_f32_32x32x16_bf16 v[160:175], v[0:3], v[100:103], v[160:175]
    v_exp_f32 v126, v126
    v_exp_f32 v127, v127
    v_add_f32 v249, v249, v126
    ds_read_b64_tr_b16 v[0:1], v243 offset:18688
    ds_read_b64_tr_b16 v[2:3], v245 offset:21760
    s_waitcnt lgkmcnt(8)
    v_mfma_f32_32x32x16_bf16 v[176:191], v[12:15], v[96:99], v[176:191]
    v_add_f32 v249, v249, v127
    v_cvt_pk_bf16_f32 v119, v126, v127
    v_fma_f32 v128, v128, s35, -v248
    v_fma_f32 v129, v129, s35, -v248
    ds_read_b64_tr_b16 v[12:13], v244 offset:12544
    ds_read_b64_tr_b16 v[14:15], v246 offset:15616
    s_bitcmp1_b32 s25, 15
    s_cselect_b32 s44, s31, s30
    v_mfma_f32_32x32x16_bf16 v[176:191], v[4:7], v[100:103], v[176:191]
    v_exp_f32 v128, v128
    v_exp_f32 v129, v129
    v_fma_f32 v130, v130, s35, -v248
    ds_read_b64_tr_b16 v[4:5], v244 offset:18688
    ds_read_b64_tr_b16 v[6:7], v246 offset:21760
    s_waitcnt lgkmcnt(8)
    v_mfma_f32_32x32x16_bf16 v[192:207], v[24:27], v[96:99], v[192:207]
    v_add_u32 v243, s44, v243
    v_add_u32 v244, s44, v244
    v_add_u32 v245, s44, v245
    v_add_u32 v246, s44, v246
    v_add_f32 v249, v249, v128
    ds_read_b64_tr_b16 v[24:25], v243 offset:12288
    ds_read_b64_tr_b16 v[26:27], v245 offset:15360
    v_mfma_f32_32x32x16_bf16 v[192:207], v[28:31], v[100:103], v[192:207]
    v_fma_f32 v131, v131, s35, -v248
    v_add_f32 v249, v249, v129
    v_cvt_pk_bf16_f32 v128, v128, v129
    v_exp_f32 v130, v130
    ds_read_b64_tr_b16 v[28:29], v243 offset:18432
    ds_read_b64_tr_b16 v[30:31], v245 offset:21504
    s_waitcnt lgkmcnt(8)
    v_mfma_f32_32x32x16_bf16 v[208:223], v[8:11], v[96:99], v[208:223]
    v_exp_f32 v131, v131
    v_fma_f32 v132, v132, s35, -v248
    v_add_f32 v249, v249, v130
    ds_read_b64_tr_b16 v[8:9], v244 offset:12288
    ds_read_b64_tr_b16 v[10:11], v246 offset:15360
    v_mfma_f32_32x32x16_bf16 v[208:223], v[0:3], v[100:103], v[208:223]
    v_fma_f32 v133, v133, s35, -v248
    v_add_f32 v249, v249, v131
    v_cvt_pk_bf16_f32 v129, v130, v131
    v_exp_f32 v132, v132
    ds_read_b64_tr_b16 v[0:1], v244 offset:18432
    ds_read_b64_tr_b16 v[2:3], v246 offset:21504
    s_waitcnt lgkmcnt(8)
    v_mfma_f32_32x32x16_bf16 v[224:239], v[12:15], v[96:99], v[224:239]
    v_exp_f32 v133, v133
    v_fma_f32 v134, v134, s35, -v248
    v_add_f32 v249, v249, v132
    v_fma_f32 v135, v135, s35, -v248
    ds_read_b64_tr_b16 v[12:13], v243 offset:12416
    ds_read_b64_tr_b16 v[14:15], v245 offset:15488
    v_mfma_f32_32x32x16_bf16 v[224:239], v[4:7], v[100:103], v[224:239]
    s_barrier
    v_add_f32 v249, v249, v133
    v_cvt_pk_bf16_f32 v130, v132, v133
    v_exp_f32 v134, v134
    ds_read_b64_tr_b16 v[4:5], v243 offset:18560
    ds_read_b64_tr_b16 v[6:7], v245 offset:21632
L_pv7:
    s_waitcnt lgkmcnt(8)
    v_mfma_f32_32x32x16_bf16 v[144:159], v[24:27], v[112:115], v[144:159]
    v_exp_f32 v135, v135
    v_fma_f32 v136, v136, s35, -v248
    v_add_f32 v249, v249, v134
    v_fma_f32 v137, v137, s35, -v248
    ds_read_b64_tr_b16 v[24:25], v244 offset:12416
    ds_read_b64_tr_b16 v[26:27], v246 offset:15488
    v_mfma_f32_32x32x16_bf16 v[144:159], v[28:31], v[116:119], v[144:159]
    v_add_f32 v249, v249, v135
    v_cvt_pk_bf16_f32 v131, v134, v135
    v_exp_f32 v136, v136
    ds_read_b64_tr_b16 v[28:29], v244 offset:18560
    ds_read_b64_tr_b16 v[30:31], v246 offset:21632
    s_waitcnt lgkmcnt(8)
    v_mfma_f32_32x32x16_bf16 v[160:175], v[8:11], v[112:115], v[160:175]
    v_exp_f32 v137, v137
    v_fma_f32 v138, v138, s35, -v248
    v_add_f32 v249, v249, v136
    v_fma_f32 v139, v139, s35, -v248
    ds_read_b64_tr_b16 v[8:9], v243 offset:12544
    ds_read_b64_tr_b16 v[10:11], v245 offset:15616
    v_mfma_f32_32x32x16_bf16 v[160:175], v[0:3], v[116:119], v[160:175]
    v_add_f32 v249, v249, v137
    v_cvt_pk_bf16_f32 v132, v136, v137
    v_exp_f32 v138, v138
    ds_read_b64_tr_b16 v[0:1], v243 offset:18688
    ds_read_b64_tr_b16 v[2:3], v245 offset:21760
    s_waitcnt lgkmcnt(8)
    v_mfma_f32_32x32x16_bf16 v[176:191], v[12:15], v[112:115], v[176:191]
    v_exp_f32 v139, v139
    v_fma_f32 v140, v140, s35, -v248
    v_add_f32 v249, v249, v138
    v_fma_f32 v141, v141, s35, -v248
    ds_read_b64_tr_b16 v[12:13], v244 offset:12544
    ds_read_b64_tr_b16 v[14:15], v246 offset:15616
    s_bitcmp1_b32 s25, 16
    s_cselect_b32 s44, s31, s30
    v_mfma_f32_32x32x16_bf16 v[176:191], v[4:7], v[116:119], v[176:191]
    v_add_f32 v249, v249, v139
    v_cvt_pk_bf16_f32 v133, v138, v139
    v_exp_f32 v140, v140
    ds_read_b64_tr_b16 v[4:5], v244 offset:18688
    ds_read_b64_tr_b16 v[6:7], v246 offset:21760
    s_waitcnt lgkmcnt(8)
    v_mfma_f32_32x32x16_bf16 v[192:207], v[24:27], v[112:115], v[192:207]
    v_add_u32 v243, s44, v243
    v_add_u32 v244, s44, v244
    v_add_u32 v245, s44, v245
    v_add_u32 v246, s44, v246
    ds_read_b64_tr_b16 v[24:25], v243 offset:12288
    ds_read_b64_tr_b16 v[26:27], v245 offset:15360
    v_mfma_f32_32x32x16_bf16 v[192:207], v[28:31], v[116:119], v[192:207]
    v_exp_f32 v141, v141
    v_fma_f32 v142, v142, s35, -v248
    v_add_f32 v249, v249, v140
    v_fma_f32 v143, v143, s35, -v248
    ds_read_b64_tr_b16 v[28:29], v243 offset:18432
    ds_read_b64_tr_b16 v[30:31], v245 offset:21504
    s_waitcnt lgkmcnt(8)
    v_mfma_f32_32x32x16_bf16 v[208:223], v[8:11], v[112:115], v[208:223]
    v_add_f32 v249, v249, v141
    v_cvt_pk_bf16_f32 v134, v140, v141
    v_exp_f32 v142, v142
    ds_read_b64_tr_b16 v[8:9], v244 offset:12288
    ds_read_b64_tr_b16 v[10:11], v246 offset:15360
    v_mfma_f32_32x32x16_bf16 v[208:223], v[0:3], v[116:119], v[208:223]
    v_exp_f32 v143, v143
    v_add_f32 v249, v249, v142
    v_add_f32 v249, v249, v143
    v_cvt_pk_bf16_f32 v135, v142, v143
    ds_read_b64_tr_b16 v[0:1], v244 offset:18432
    ds_read_b64_tr_b16 v[2:3], v246 offset:21504
    s_waitcnt lgkmcnt(8)
    v_mfma_f32_32x32x16_bf16 v[224:239], v[12:15], v[112:115], v[224:239]
    ds_read_b64_tr_b16 v[12:13], v243 offset:12416
    ds_read_b64_tr_b16 v[14:15], v245 offset:15488
    v_mfma_f32_32x32x16_bf16 v[224:239], v[4:7], v[116:119], v[224:239]
    s_barrier
    ds_read_b64_tr_b16 v[4:5], v243 offset:18560
    ds_read_b64_tr_b16 v[6:7], v245 offset:21632
L_pv8:
    s_bitcmp0_b32 s36, 8
    s_cbranch_scc1 L_pv8_inv
    s_waitcnt lgkmcnt(8)
    v_mfma_f32_32x32x16_bf16 v[144:159], v[24:27], v[128:131], v[144:159]
    v_mov_b32 v250, v249
    v_and_b32 v44, 31, v254
    v_and_b32 v46, 7, v254
    v_permlane32_swap_b32 v250, v249
    v_lshlrev_b32 v45, 7, v44
    v_add_f32 v249, v250, v249
    ds_read_b64_tr_b16 v[24:25], v244 offset:12416
    ds_read_b64_tr_b16 v[26:27], v246 offset:15488
    v_mfma_f32_32x32x16_bf16 v[144:159], v[28:31], v[132:135], v[144:159]
    v_lshl_add_u32 v45, v46, 4, v45
    v_rcp_f32 v252, v249
    v_lshrrev_b32 v44, 5, v254
    v_lshl_add_u32 v45, v44, 3, v45
    v_add_u32 v32, s47, v45
    v_xor_b32 v33, 16, v32
    ds_read_b64_tr_b16 v[28:29], v244 offset:18560
    ds_read_b64_tr_b16 v[30:31], v246 offset:21632
    s_waitcnt lgkmcnt(8)
    v_mfma_f32_32x32x16_bf16 v[160:175], v[8:11], v[128:131], v[160:175]
    v_xor_b32 v34, 32, v32
    v_xor_b32 v35, 48, v32
    v_xor_b32 v36, 64, v32
    v_xor_b32 v37, 80, v32
    v_xor_b32 v38, 96, v32
    v_xor_b32 v39, 112, v32
    ds_read_b64_tr_b16 v[8:9], v243 offset:12544
    ds_read_b64_tr_b16 v[10:11], v245 offset:15616
    v_mfma_f32_32x32x16_bf16 v[160:175], v[0:3], v[132:135], v[160:175]
    v_mul_f32 v144, v252, v144
    v_mul_f32 v145, v252, v145
    v_mul_f32 v146, v252, v146
    v_mul_f32 v147, v252, v147
    v_cvt_pk_bf16_f32 v144, v144, v145
    v_cvt_pk_bf16_f32 v145, v146, v147
    ds_read_b64_tr_b16 v[0:1], v243 offset:18688
    ds_read_b64_tr_b16 v[2:3], v245 offset:21760
    ds_write_b64 v32, v[144:145] offset:0
    s_waitcnt lgkmcnt(9)
    v_mfma_f32_32x32x16_bf16 v[176:191], v[12:15], v[128:131], v[176:191]
    v_mul_f32 v148, v252, v148
    v_mul_f32 v149, v252, v149
    v_mul_f32 v150, v252, v150
    v_mul_f32 v151, v252, v151
    v_cvt_pk_bf16_f32 v148, v148, v149
    v_cvt_pk_bf16_f32 v149, v150, v151
    ds_read_b64_tr_b16 v[12:13], v244 offset:12544
    ds_read_b64_tr_b16 v[14:15], v246 offset:15616
    ds_write_b64 v33, v[148:149] offset:0
    v_mfma_f32_32x32x16_bf16 v[176:191], v[4:7], v[132:135], v[176:191]
    v_mul_f32 v152, v252, v152
    v_mul_f32 v153, v252, v153
    v_mul_f32 v154, v252, v154
    v_mul_f32 v155, v252, v155
    v_cvt_pk_bf16_f32 v152, v152, v153
    v_cvt_pk_bf16_f32 v153, v154, v155
    ds_read_b64_tr_b16 v[4:5], v244 offset:18688
    ds_read_b64_tr_b16 v[6:7], v246 offset:21760
    ds_write_b64 v34, v[152:153] offset:0
    s_waitcnt lgkmcnt(11)
    v_mfma_f32_32x32x16_bf16 v[192:207], v[24:27], v[128:131], v[192:207]
    v_mul_f32 v156, v252, v156
    v_mul_f32 v157, v252, v157
    v_mul_f32 v158, v252, v158
    v_mul_f32 v159, v252, v159
    v_cvt_pk_bf16_f32 v156, v156, v157
    v_cvt_pk_bf16_f32 v157, v158, v159
    ds_write_b64 v35, v[156:157] offset:0
    v_mfma_f32_32x32x16_bf16 v[192:207], v[28:31], v[132:135], v[192:207]
    v_mul_f32 v160, v252, v160
    v_mul_f32 v161, v252, v161
    v_mul_f32 v162, v252, v162
    v_mul_f32 v163, v252, v163
    v_cvt_pk_bf16_f32 v160, v160, v161
    v_cvt_pk_bf16_f32 v161, v162, v163
    ds_write_b64 v36, v[160:161] offset:0
    s_waitcnt lgkmcnt(9)
    v_mfma_f32_32x32x16_bf16 v[208:223], v[8:11], v[128:131], v[208:223]
    v_mul_f32 v164, v252, v164
    v_mul_f32 v165, v252, v165
    v_mul_f32 v166, v252, v166
    v_mul_f32 v167, v252, v167
    v_cvt_pk_bf16_f32 v164, v164, v165
    v_cvt_pk_bf16_f32 v165, v166, v167
    ds_write_b64 v37, v[164:165] offset:0
    v_mfma_f32_32x32x16_bf16 v[208:223], v[0:3], v[132:135], v[208:223]
    v_mul_f32 v168, v252, v168
    v_mul_f32 v169, v252, v169
    v_mul_f32 v170, v252, v170
    v_mul_f32 v171, v252, v171
    v_cvt_pk_bf16_f32 v168, v168, v169
    v_cvt_pk_bf16_f32 v169, v170, v171
    ds_write_b64 v38, v[168:169] offset:0
    s_waitcnt lgkmcnt(5)
    v_mfma_f32_32x32x16_bf16 v[224:239], v[12:15], v[128:131], v[224:239]
    v_mul_f32 v172, v252, v172
    v_mul_f32 v173, v252, v173
    v_mul_f32 v174, v252, v174
    v_mul_f32 v175, v252, v175
    v_cvt_pk_bf16_f32 v172, v172, v173
    v_cvt_pk_bf16_f32 v173, v174, v175
    ds_write_b64 v39, v[172:173] offset:0
    v_mfma_f32_32x32x16_bf16 v[224:239], v[4:7], v[132:135], v[224:239]
L_e:
    s_cmp_gt_u32 s20, 5
    s_cbranch_scc1 L_ns19
    s_waitcnt vmcnt(0)
    s_barrier
L_ns19:
    v_lshrrev_b32 v44, 3, v254
    v_xor_b32 v45, v44, v46
    v_lshlrev_b32 v45, 4, v45
    v_lshl_add_u32 v45, v44, 7, v45
    v_add_u32 v40, s47, v45
    v_mul_u32_u24 v44, 384, v44
    v_lshl_add_u32 v41, v46, 4, v44
    s_movk_i32 s43, 9216
    ds_read_b128 v[48:51], v40 offset:0
    ds_read_b128 v[52:55], v40 offset:1024
    ds_read_b128 v[56:59], v40 offset:2048
    ds_read_b128 v[60:63], v40 offset:3072
    v_mul_f32 v176, v252, v176
    v_mul_f32 v177, v252, v177
    v_mul_f32 v178, v252, v178
    v_mul_f32 v179, v252, v179
    v_cvt_pk_bf16_f32 v176, v176, v177
    v_cvt_pk_bf16_f32 v177, v178, v179
    ds_write_b64 v32, v[176:177] offset:4096
    v_mul_f32 v180, v252, v180
    v_mul_f32 v181, v252, v181
    v_mul_f32 v182, v252, v182
    v_mul_f32 v183, v252, v183
    v_cvt_pk_bf16_f32 v180, v180, v181
    v_cvt_pk_bf16_f32 v181, v182, v183
    ds_write_b64 v33, v[180:181] offset:4096
    s_waitcnt lgkmcnt(5)
    buffer_store_dwordx4 v[48:51], v41, s[16:19], 0 offen sc1 nt
    v_mul_f32 v184, v252, v184
    v_mul_f32 v185, v252, v185
    v_mul_f32 v186, v252, v186
    v_mul_f32 v187, v252, v187
    v_cvt_pk_bf16_f32 v184, v184, v185
    v_cvt_pk_bf16_f32 v185, v186, v187
    ds_write_b64 v34, v[184:185] offset:4096
    v_mul_f32 v188, v252, v188
    v_mul_f32 v189, v252, v189
    v_mul_f32 v190, v252, v190
    s_waitcnt lgkmcnt(5)
    buffer_store_dwordx4 v[52:55], v41, s[16:19], s45 offen sc1 nt
    v_mul_f32 v191, v252, v191
    v_cvt_pk_bf16_f32 v188, v188, v189
    v_cvt_pk_bf16_f32 v189, v190, v191
    ds_write_b64 v35, v[188:189] offset:4096
    v_mul_f32 v192, v252, v192
    v_mul_f32 v193, v252, v193
    v_mul_f32 v194, v252, v194
    v_mul_f32 v195, v252, v195
    v_cvt_pk_bf16_f32 v192, v192, v193
    v_cvt_pk_bf16_f32 v193, v194, v195
    s_waitcnt lgkmcnt(5)
    buffer_store_dwordx4 v[56:59], v41, s[16:19], s46 offen sc1 nt
    ds_write_b64 v36, v[192:193] offset:4096
    v_mul_f32 v196, v252, v196
    v_mul_f32 v197, v252, v197
    v_mul_f32 v198, v252, v198
    v_mul_f32 v199, v252, v199
    v_cvt_pk_bf16_f32 v196, v196, v197
    v_cvt_pk_bf16_f32 v197, v198, v199
    ds_write_b64 v37, v[196:197] offset:4096
    v_mul_f32 v200, v252, v200
    v_mul_f32 v201, v252, v201
    s_waitcnt lgkmcnt(6)
    buffer_store_dwordx4 v[60:63], v41, s[16:19], s43 offen sc1 nt
    v_mul_f32 v202, v252, v202
    v_mul_f32 v203, v252, v203
    v_cvt_pk_bf16_f32 v200, v200, v201
    v_cvt_pk_bf16_f32 v201, v202, v203
    ds_write_b64 v38, v[200:201] offset:4096
    v_mul_f32 v204, v252, v204
    v_mul_f32 v205, v252, v205
    v_mul_f32 v206, v252, v206
    v_mul_f32 v207, v252, v207
    v_cvt_pk_bf16_f32 v204, v204, v205
    v_cvt_pk_bf16_f32 v205, v206, v207
    ds_write_b64 v39, v[204:205] offset:4096
    ds_read_b128 v[64:67], v40 offset:4096
    ds_read_b128 v[68:71], v40 offset:5120
    ds_read_b128 v[72:75], v40 offset:6144
    ds_read_b128 v[76:79], v40 offset:7168
    s_cmp_gt_u32 s20, 4
    s_cbranch_scc1 L_ns20
    s_waitcnt vmcnt(63)
    s_barrier
L_ns20:
    v_mul_f32 v208, v252, v208
    v_mul_f32 v209, v252, v209
    v_mul_f32 v210, v252, v210
    v_mul_f32 v211, v252, v211
    v_cvt_pk_bf16_f32 v208, v208, v209
    v_cvt_pk_bf16_f32 v209, v210, v211
    ds_write_b64 v32, v[208:209] offset:8192
    s_waitcnt lgkmcnt(4)
    buffer_store_dwordx4 v[64:67], v41, s[16:19], 0 offen offset:128 sc1 nt
    v_mul_f32 v212, v252, v212
    v_mul_f32 v213, v252, v213
    v_mul_f32 v214, v252, v214
    v_mul_f32 v215, v252, v215
    v_cvt_pk_bf16_f32 v212, v212, v213
    v_cvt_pk_bf16_f32 v213, v214, v215
    ds_write_b64 v33, v[212:213] offset:8192
    v_mul_f32 v216, v252, v216
    v_mul_f32 v217, v252, v217
    v_mul_f32 v218, v252, v218
    v_mul_f32 v219, v252, v219
    v_cvt_pk_bf16_f32 v216, v216, v217
    s_waitcnt lgkmcnt(4)
    buffer_store_dwordx4 v[68:71], v41, s[16:19], s45 offen offset:128 sc1 nt
    v_cvt_pk_bf16_f32 v217, v218, v219
    ds_write_b64 v34, v[216:217] offset:8192
    v_mul_f32 v220, v252, v220
    v_mul_f32 v221, v252, v221
    v_mul_f32 v222, v252, v222
    v_mul_f32 v223, v252, v223
    v_cvt_pk_bf16_f32 v220, v220, v221
    v_cvt_pk_bf16_f32 v221, v222, v223
    ds_write_b64 v35, v[220:221] offset:8192
    v_mul_f32 v224, v252, v224
    v_mul_f32 v225, v252, v225
    v_mul_f32 v226, v252, v226
    s_waitcnt lgkmcnt(5)
    buffer_store_dwordx4 v[72:75], v41, s[16:19], s46 offen offset:128 sc1 nt
    v_mul_f32 v227, v252, v227
    v_cvt_pk_bf16_f32 v224, v224, v225
    v_cvt_pk_bf16_f32 v225, v226, v227
    ds_write_b64 v36, v[224:225] offset:8192
    v_mul_f32 v228, v252, v228
    v_mul_f32 v229, v252, v229
    v_mul_f32 v230, v252, v230
    v_mul_f32 v231, v252, v231
    v_cvt_pk_bf16_f32 v228, v228, v229
    v_cvt_pk_bf16_f32 v229, v230, v231
    ds_write_b64 v37, v[228:229] offset:8192
    v_mul_f32 v232, v252, v232
    s_waitcnt lgkmcnt(6)
    buffer_store_dwordx4 v[76:79], v41, s[16:19], s43 offen offset:128 sc1 nt
    v_mul_f32 v233, v252, v233
    v_mul_f32 v234, v252, v234
    v_mul_f32 v235, v252, v235
    v_cvt_pk_bf16_f32 v232, v232, v233
    v_cvt_pk_bf16_f32 v233, v234, v235
    ds_write_b64 v38, v[232:233] offset:8192
    v_mul_f32 v236, v252, v236
    v_mul_f32 v237, v252, v237
    v_mul_f32 v238, v252, v238
    v_mul_f32 v239, v252, v239
    v_cvt_pk_bf16_f32 v236, v236, v237
    v_cvt_pk_bf16_f32 v237, v238, v239
    ds_write_b64 v39, v[236:237] offset:8192
    ds_read_b128 v[80:83], v40 offset:8192
    ds_read_b128 v[84:87], v40 offset:9216
    ds_read_b128 v[88:91], v40 offset:10240
    ds_read_b128 v[92:95], v40 offset:11264
    s_waitcnt lgkmcnt(3)
    buffer_store_dwordx4 v[80:83], v41, s[16:19], 0 offen offset:256 sc1 nt
    s_waitcnt lgkmcnt(2)
    buffer_store_dwordx4 v[84:87], v41, s[16:19], s45 offen offset:256 sc1 nt
    s_waitcnt lgkmcnt(1)
    buffer_store_dwordx4 v[88:91], v41, s[16:19], s46 offen offset:256 sc1 nt
    s_waitcnt lgkmcnt(0)
    buffer_store_dwordx4 v[92:95], v41, s[16:19], s43 offen offset:256 sc1 nt
L_post:
    s_cmp_gt_u32 s20, 3
    s_cbranch_scc1 L_fin
    s_barrier
    s_add_u32 s20, s20, 1
    s_branch L_post
L_fin:
L_end:
    s_endpgm
L_pv1_inv:
    s_waitcnt lgkmcnt(0)
    s_bitcmp1_b32 s24, 14
    s_cselect_b32 m0, s32, s33
    s_cselect_b32 s14, s83, 0
    buffer_load_dwordx4 v240, s[12:15], s21 offen lds
    buffer_load_dwordx4 v241, s[12:15], s21 offen offset:1024 lds
    buffer_load_dwordx4 v242, s[12:15], s21 offen offset:2048 lds
    s_add_u32 s21, s21, s22
    s_add_u32 s37, s21, s23
    s_min_u32 s21, s21, s37
    s_bitcmp1_b32 s25, 14
    s_cselect_b32 s37, s31, s30
    s_add_u32 s32, s32, s37
    s_waitcnt vmcnt(6)
    s_barrier
L_nsx12:
L_pv2_inv:
    s_waitcnt lgkmcnt(0)
    s_bitcmp1_b32 s24, 15
    s_cselect_b32 m0, s32, s33
    s_cselect_b32 s14, s83, 0
    buffer_load_dwordx4 v240, s[12:15], s21 offen lds
    buffer_load_dwordx4 v241, s[12:15], s21 offen offset:1024 lds
    buffer_load_dwordx4 v242, s[12:15], s21 offen offset:2048 lds
    s_add_u32 s21, s21, s22
    s_add_u32 s37, s21, s23
    s_min_u32 s21, s21, s37
    s_bitcmp1_b32 s25, 15
    s_cselect_b32 s37, s31, s30
    s_add_u32 s32, s32, s37
    s_waitcnt vmcnt(6)
    s_barrier
L_nsx13:
L_pv3_inv:
    s_waitcnt lgkmcnt(0)
    s_bitcmp1_b32 s24, 16
    s_cselect_b32 m0, s32, s33
    s_cselect_b32 s14, s83, 0
    buffer_load_dwordx4 v240, s[12:15], s21 offen lds
    buffer_load_dwordx4 v241, s[12:15], s21 offen offset:1024 lds
    buffer_load_dwordx4 v242, s[12:15], s21 offen offset:2048 lds
    s_add_u32 s21, s21, s22
    s_add_u32 s37, s21, s23
    s_min_u32 s21, s21, s37
    s_bitcmp1_b32 s25, 16
    s_cselect_b32 s37, s31, s30
    s_add_u32 s32, s32, s37
    s_waitcnt vmcnt(6)
    s_barrier
L_nsx14:
L_pv4_inv:
    s_waitcnt lgkmcnt(0)
    s_bitcmp1_b32 s24, 17
    s_cselect_b32 m0, s32, s33
    s_cselect_b32 s14, s83, 0
    buffer_load_dwordx4 v240, s[12:15], s21 offen lds
    buffer_load_dwordx4 v241, s[12:15], s21 offen offset:1024 lds
    buffer_load_dwordx4 v242, s[12:15], s21 offen offset:2048 lds
    s_add_u32 s21, s21, s22
    s_add_u32 s37, s21, s23
    s_min_u32 s21, s21, s37
    s_bitcmp1_b32 s25, 17
    s_cselect_b32 s37, s31, s30
    s_add_u32 s32, s32, s37
    s_waitcnt vmcnt(6)
    s_barrier
L_nsx15:
L_pv5_inv:
    s_waitcnt lgkmcnt(0)
    s_bitcmp1_b32 s24, 18
    s_cselect_b32 m0, s32, s33
    s_cselect_b32 s14, s83, 0
    buffer_load_dwordx4 v240, s[12:15], s21 offen lds
    buffer_load_dwordx4 v241, s[12:15], s21 offen offset:1024 lds
    buffer_load_dwordx4 v242, s[12:15], s21 offen offset:2048 lds
    s_add_u32 s21, s21, s22
    s_add_u32 s37, s21, s23
    s_min_u32 s21, s21, s37
    s_bitcmp1_b32 s25, 18
    s_cselect_b32 s37, s31, s30
    s_add_u32 s32, s32, s37
    s_waitcnt vmcnt(6)
    s_barrier
L_nsx16:
L_pv6_inv:
    s_waitcnt lgkmcnt(0)
    s_bitcmp1_b32 s24, 19
    s_cselect_b32 m0, s32, s33
    s_cselect_b32 s14, s83, 0
    buffer_load_dwordx4 v240, s[12:15], s21 offen lds
    buffer_load_dwordx4 v241, s[12:15], s21 offen offset:1024 lds
    buffer_load_dwordx4 v242, s[12:15], s21 offen offset:2048 lds
    s_add_u32 s21, s21, s22
    s_add_u32 s37, s21, s23
    s_min_u32 s21, s21, s37
    s_bitcmp1_b32 s25, 19
    s_cselect_b32 s37, s31, s30
    s_add_u32 s32, s32, s37
    s_waitcnt vmcnt(6)
    s_barrier
L_nsx17:
L_pv7_inv:
    s_waitcnt lgkmcnt(0)
    s_bitcmp1_b32 s24, 20
    s_cselect_b32 m0, s32, s33
    s_cselect_b32 s14, s83, 0
    buffer_load_dwordx4 v240, s[12:15], s21 offen lds
    buffer_load_dwordx4 v241, s[12:15], s21 offen offset:1024 lds
    buffer_load_dwordx4 v242, s[12:15], s21 offen offset:2048 lds
    s_add_u32 s21, s21, s22
    s_add_u32 s37, s21, s23
    s_min_u32 s21, s21, s37
    s_bitcmp1_b32 s25, 20
    s_cselect_b32 s37, s31, s30
    s_add_u32 s32, s32, s37
    s_cmp_gt_u32 s20, 6
    s_cbranch_scc1 L_nsx18
    s_waitcnt vmcnt(6)
    s_barrier
L_nsx18:
L_pv8_inv:
    s_waitcnt lgkmcnt(0)
    s_waitcnt lgkmcnt(0)
    s_nop 7
    s_nop 3
    v_mov_b32 v250, v249
    v_and_b32 v44, 31, v254
    v_and_b32 v46, 7, v254
    v_permlane32_swap_b32 v250, v249
    v_lshlrev_b32 v45, 7, v44
    v_add_f32 v249, v250, v249
    v_lshl_add_u32 v45, v46, 4, v45
    v_rcp_f32 v252, v249
    v_lshrrev_b32 v44, 5, v254
    v_lshl_add_u32 v45, v44, 3, v45
    v_add_u32 v32, s47, v45
    v_xor_b32 v33, 16, v32
    v_xor_b32 v34, 32, v32
    v_xor_b32 v35, 48, v32
    v_xor_b32 v36, 64, v32
    v_xor_b32 v37, 80, v32
    v_xor_b32 v38, 96, v32
    v_xor_b32 v39, 112, v32
    v_mul_f32 v144, v252, v144
    v_mul_f32 v145, v252, v145
    v_mul_f32 v146, v252, v146
    v_mul_f32 v147, v252, v147
    v_cvt_pk_bf16_f32 v144, v144, v145
    v_cvt_pk_bf16_f32 v145, v146, v147
    ds_write_b64 v32, v[144:145] offset:0
    v_mul_f32 v148, v252, v148
    v_mul_f32 v149, v252, v149
    v_mul_f32 v150, v252, v150
    v_mul_f32 v151, v252, v151
    v_cvt_pk_bf16_f32 v148, v148, v149
    v_cvt_pk_bf16_f32 v149, v150, v151
    ds_write_b64 v33, v[148:149] offset:0
    v_mul_f32 v152, v252, v152
    v_mul_f32 v153, v252, v153
    v_mul_f32 v154, v252, v154
    v_mul_f32 v155, v252, v155
    v_cvt_pk_bf16_f32 v152, v152, v153
    v_cvt_pk_bf16_f32 v153, v154, v155
    ds_write_b64 v34, v[152:153] offset:0
    v_mul_f32 v156, v252, v156
    v_mul_f32 v157, v252, v157
    v_mul_f32 v158, v252, v158
    v_mul_f32 v159, v252, v159
    v_cvt_pk_bf16_f32 v156, v156, v157
    v_cvt_pk_bf16_f32 v157, v158, v159
    ds_write_b64 v35, v[156:157] offset:0
    v_mul_f32 v160, v252, v160
    v_mul_f32 v161, v252, v161
    v_mul_f32 v162, v252, v162
    v_mul_f32 v163, v252, v163
    v_cvt_pk_bf16_f32 v160, v160, v161
    v_cvt_pk_bf16_f32 v161, v162, v163
    ds_write_b64 v36, v[160:161] offset:0
    v_mul_f32 v164, v252, v164
    v_mul_f32 v165, v252, v165
    v_mul_f32 v166, v252, v166
    v_mul_f32 v167, v252, v167
    v_cvt_pk_bf16_f32 v164, v164, v165
    v_cvt_pk_bf16_f32 v165, v166, v167
    ds_write_b64 v37, v[164:165] offset:0
    v_mul_f32 v168, v252, v168
    v_mul_f32 v169, v252, v169
    v_mul_f32 v170, v252, v170
    v_mul_f32 v171, v252, v171
    v_cvt_pk_bf16_f32 v168, v168, v169
    v_cvt_pk_bf16_f32 v169, v170, v171
    ds_write_b64 v38, v[168:169] offset:0
    v_mul_f32 v172, v252, v172
    v_mul_f32 v173, v252, v173
    v_mul_f32 v174, v252, v174
    v_mul_f32 v175, v252, v175
    v_cvt_pk_bf16_f32 v172, v172, v173
    v_cvt_pk_bf16_f32 v173, v174, v175
    ds_write_b64 v39, v[172:173] offset:0
    s_waitcnt lgkmcnt(0)
    s_branch L_e
L_qk1b:
    s_cbranch_execz L_warm1
    s_bitcmp0_b32 s36, 1
    s_cbranch_scc1 L_qk1_inv
    s_waitcnt lgkmcnt(6)
    v_mfma_f32_32x32x16_bf16 v[16:31], v[192:195], v[144:147], 0
    v_add_u32 v243, s44, v243
    v_add_u32 v244, s44, v244
    v_add_u32 v245, s44, v245
    v_add_u32 v246, s44, v246
    ds_read_b128 v[192:195], v243 offset:0
    v_mfma_f32_32x32x16_bf16 v[16:31], v[196:199], v[148:151], v[16:31]
    ds_read_b128 v[196:199], v244 offset:0
    s_bitcmp1_b32 s29, 5
    s_cselect_b64 s[12:13], s[26:27], s[12:13]
    s_cselect_b32 s21, s28, s21
    v_mfma_f32_32x32x16_bf16 v[16:31], v[200:203], v[152:155], v[16:31]
    v_max3_f32 v248, v248, v0, v1
    v_max3_f32 v248, v248, v2, v3
    ds_read_b128 v[200:203], v245 offset:0
    s_bitcmp1_b32 s24, 5
    s_cselect_b32 m0, s32, s33
    s_cselect_b32 s14, s83, 0
    buffer_load_dwordx4 v240, s[12:15], s21 offen lds
    v_mfma_f32_32x32x16_bf16 v[16:31], v[204:207], v[156:159], v[16:31]
    v_max3_f32 v248, v248, v4, v5
    v_max3_f32 v248, v248, v6, v7
    v_max3_f32 v248, v248, v8, v9
    ds_read_b128 v[204:207], v246 offset:0
    buffer_load_dwordx4 v241, s[12:15], s21 offen offset:1024 lds
    v_mfma_f32_32x32x16_bf16 v[16:31], v[208:211], v[160:163], v[16:31]
    v_max3_f32 v248, v248, v10, v11
    v_max3_f32 v248, v248, v12, v13
    v_max3_f32 v248, v248, v14, v15
    ds_read_b128 v[208:211], v243 offset:128
    buffer_load_dwordx4 v242, s[12:15], s21 offen offset:2048 lds
    v_mfma_f32_32x32x16_bf16 v[16:31], v[212:215], v[164:167], v[16:31]
    ds_read_b128 v[212:215], v244 offset:128
    s_add_u32 s21, s21, s22
    s_add_u32 s37, s21, s23
    s_min_u32 s21, s21, s37
    s_waitcnt lgkmcnt(6)
    v_mfma_f32_32x32x16_bf16 v[16:31], v[216:219], v[168:171], v[16:31]
    ds_read_b128 v[216:219], v245 offset:128
    s_bitcmp1_b32 s25, 5
    s_cselect_b32 s37, s31, s30
    s_add_u32 s32, s32, s37
    v_mfma_f32_32x32x16_bf16 v[16:31], v[220:223], v[172:175], v[16:31]
    ds_read_b128 v[220:223], v246 offset:128
    v_mfma_f32_32x32x16_bf16 v[16:31], v[224:227], v[176:179], v[16:31]
    ds_read_b128 v[224:227], v243 offset:256
    v_mfma_f32_32x32x16_bf16 v[16:31], v[228:231], v[180:183], v[16:31]
    ds_read_b128 v[228:231], v244 offset:256
    v_mfma_f32_32x32x16_bf16 v[16:31], v[232:235], v[184:187], v[16:31]
    ds_read_b128 v[232:235], v245 offset:256
    s_bitcmp1_b32 s25, 2
    s_cselect_b32 s44, s31, s30
    v_mfma_f32_32x32x16_bf16 v[16:31], v[236:239], v[188:191], v[16:31]
    s_waitcnt vmcnt(6)
    s_barrier
    ds_read_b128 v[236:239], v246 offset:256
L_qk2b:
    s_bitcmp0_b32 s36, 2
    s_cbranch_scc1 L_qk2_inv
    s_waitcnt lgkmcnt(6)
    v_mfma_f32_32x32x16_bf16 v[32:47], v[192:195], v[144:147], 0
    v_add_u32 v243, s44, v243
    v_add_u32 v244, s44, v244
    v_add_u32 v245, s44, v245
    v_add_u32 v246, s44, v246
    ds_read_b128 v[192:195], v243 offset:0
    v_mfma_f32_32x32x16_bf16 v[32:47], v[196:199], v[148:151], v[32:47]
    ds_read_b128 v[196:199], v244 offset:0
    v_mfma_f32_32x32x16_bf16 v[32:47], v[200:203], v[152:155], v[32:47]
    v_max3_f32 v248, v248, v16, v17
    v_max3_f32 v248, v248, v18, v19
    v_max3_f32 v248, v248, v20, v21
    ds_read_b128 v[200:203], v245 offset:0
    s_bitcmp1_b32 s24, 6
    s_cselect_b32 m0, s32, s33
    s_cselect_b32 s14, s83, 0
    buffer_load_dwordx4 v240, s[12:15], s21 offen lds
    v_mfma_f32_32x32x16_bf16 v[32:47], v[204:207], v[156:159], v[32:47]
    v_max3_f32 v248, v248, v22, v23
    v_max3_f32 v248, v248, v24, v25
    v_max3_f32 v248, v248, v26, v27
    ds_read_b128 v[204:207], v246 offset:0
    buffer_load_dwordx4 v241, s[12:15], s21 offen offset:1024 lds
    v_mfma_f32_32x32x16_bf16 v[32:47], v[208:211], v[160:163], v[32:47]
    v_max3_f32 v248, v248, v28, v29
    v_max3_f32 v248, v248, v30, v31
    v_mul_f32 v251, s35, v248
    ds_read_b128 v[208:211], v243 offset:128
    buffer_load_dwordx4 v242, s[12:15], s21 offen offset:2048 lds
    v_mfma_f32_32x32x16_bf16 v[32:47], v[212:215], v[164:167], v[32:47]
    v_fma_f32 v0, v0, s35, -v251
    v_fma_f32 v1, v1, s35, -v251
    v_exp_f32 v0, v0
    v_exp_f32 v1, v1
    v_fma_f32 v2, v2, s35, -v251
    v_add_f32 v249, v249, v0
    v_fma_f32 v3, v3, s35, -v251
    v_add_f32 v249, v249, v1
    v_exp_f32 v2, v2
    v_exp_f32 v3, v3
    v_fma_f32 v4, v4, s35, -v251
    v_add_f32 v249, v249, v2
    v_fma_f32 v5, v5, s35, -v251
    v_add_f32 v249, v249, v3
    v_exp_f32 v4, v4
    ds_read_b128 v[212:215], v244 offset:128
    s_add_u32 s21, s21, s22
    s_add_u32 s37, s21, s23
    s_min_u32 s21, s21, s37
    s_waitcnt lgkmcnt(6)
    v_mfma_f32_32x32x16_bf16 v[32:47], v[216:219], v[168:171], v[32:47]
    v_exp_f32 v5, v5
    v_fma_f32 v6, v6, s35, -v251
    v_add_f32 v249, v249, v4
    v_fma_f32 v7, v7, s35, -v251
    v_add_f32 v249, v249, v5
    v_exp_f32 v6, v6
    v_exp_f32 v7, v7
    v_fma_f32 v8, v8, s35, -v251
    v_add_f32 v249, v249, v6
    v_fma_f32 v9, v9, s35, -v251
    v_add_f32 v249, v249, v7
    v_exp_f32 v8, v8
    v_exp_f32 v9, v9
    v_fma_f32 v10, v10, s35, -v251
    v_add_f32 v249, v249, v8
    v_fma_f32 v11, v11, s35, -v251
    v_add_f32 v249, v249, v9
    ds_read_b128 v[216:219], v245 offset:128
    s_bitcmp1_b32 s25, 6
    s_cselect_b32 s37, s31, s30
    s_add_u32 s32, s32, s37
    v_mfma_f32_32x32x16_bf16 v[32:47], v[220:223], v[172:175], v[32:47]
    v_exp_f32 v10, v10
    v_exp_f32 v11, v11
    v_fma_f32 v12, v12, s35, -v251
    v_add_f32 v249, v249, v10
    v_fma_f32 v13, v13, s35, -v251
    v_add_f32 v249, v249, v11
    v_exp_f32 v12, v12
    v_exp_f32 v13, v13
    v_fma_f32 v14, v14, s35, -v251
    v_add_f32 v249, v249, v12
    v_fma_f32 v15, v15, s35, -v251
    v_add_f32 v249, v249, v13
    v_exp_f32 v14, v14
    v_exp_f32 v15, v15
    v_add_f32 v249, v249, v14
    v_add_f32 v249, v249, v15
    ds_read_b128 v[220:223], v246 offset:128
    v_mfma_f32_32x32x16_bf16 v[32:47], v[224:227], v[176:179], v[32:47]
    v_fma_f32 v16, v16, s35, -v251
    v_fma_f32 v17, v17, s35, -v251
    v_exp_f32 v16, v16
    v_exp_f32 v17, v17
    v_fma_f32 v18, v18, s35, -v251
    v_add_f32 v249, v249, v16
    v_fma_f32 v19, v19, s35, -v251
    v_add_f32 v249, v249, v17
    v_exp_f32 v18, v18
    v_exp_f32 v19, v19
    v_fma_f32 v20, v20, s35, -v251
    v_add_f32 v249, v249, v18
    v_fma_f32 v21, v21, s35, -v251
    v_add_f32 v249, v249, v19
    v_exp_f32 v20, v20
    ds_read_b128 v[224:227], v243 offset:256
    v_mfma_f32_32x32x16_bf16 v[32:47], v[228:231], v[180:183], v[32:47]
    v_exp_f32 v21, v21
    v_fma_f32 v22, v22, s35, -v251
    v_add_f32 v249, v249, v20
    v_fma_f32 v23, v23, s35, -v251
    v_add_f32 v249, v249, v21
    v_exp_f32 v22, v22
    v_exp_f32 v23, v23
    v_fma_f32 v24, v24, s35, -v251
    v_add_f32 v249, v249, v22
    v_fma_f32 v25, v25, s35, -v251
    v_add_f32 v249, v249, v23
    v_exp_f32 v24, v24
    v_exp_f32 v25, v25
    v_fma_f32 v26, v26, s35, -v251
    v_add_f32 v249, v249, v24
    v_fma_f32 v27, v27, s35, -v251
    v_add_f32 v249, v249, v25
    ds_read_b128 v[228:231], v244 offset:256
    v_mfma_f32_32x32x16_bf16 v[32:47], v[232:235], v[184:187], v[32:47]
    v_exp_f32 v26, v26
    v_exp_f32 v27, v27
    v_fma_f32 v28, v28, s35, -v251
    v_add_f32 v249, v249, v26
    v_fma_f32 v29, v29, s35, -v251
    v_add_f32 v249, v249, v27
    v_exp_f32 v28, v28
    v_exp_f32 v29, v29
    v_fma_f32 v30, v30, s35, -v251
    v_add_f32 v249, v249, v28
    v_fma_f32 v31, v31, s35, -v251
    v_add_f32 v249, v249, v29
    v_exp_f32 v30, v30
    v_exp_f32 v31, v31
    v_add_f32 v249, v249, v30
    v_add_f32 v249, v249, v31
    ds_read_b128 v[232:235], v245 offset:256
    s_bitcmp1_b32 s25, 3
    s_cselect_b32 s44, s31, s30
    v_mfma_f32_32x32x16_bf16 v[32:47], v[236:239], v[188:191], v[32:47]
    s_waitcnt vmcnt(6)
    s_barrier
    ds_read_b128 v[236:239], v246 offset:256
L_qk3b:
    s_bitcmp0_b32 s36, 3
    s_cbranch_scc1 L_qk3_inv
    s_waitcnt lgkmcnt(6)
    v_mfma_f32_32x32x16_bf16 v[48:63], v[192:195], v[144:147], 0
    v_add_u32 v243, s44, v243
    v_add_u32 v244, s44, v244
    v_add_u32 v245, s44, v245
    v_add_u32 v246, s44, v246
    ds_read_b128 v[192:195], v243 offset:0
    v_mfma_f32_32x32x16_bf16 v[48:63], v[196:199], v[148:151], v[48:63]
    ds_read_b128 v[196:199], v244 offset:0
    v_mfma_f32_32x32x16_bf16 v[48:63], v[200:203], v[152:155], v[48:63]
    v_max3_f32 v248, v248, v32, v33
    v_max3_f32 v248, v248, v34, v35
    ds_read_b128 v[200:203], v245 offset:0
    s_bitcmp1_b32 s24, 7
    s_cselect_b32 m0, s32, s33
    s_cselect_b32 s14, s83, 0
    buffer_load_dwordx4 v240, s[12:15], s21 offen lds
    v_mfma_f32_32x32x16_bf16 v[48:63], v[204:207], v[156:159], v[48:63]
    v_max3_f32 v248, v248, v36, v37
    v_max3_f32 v248, v248, v38, v39
    v_max3_f32 v248, v248, v40, v41
    ds_read_b128 v[204:207], v246 offset:0
    buffer_load_dwordx4 v241, s[12:15], s21 offen offset:1024 lds
    v_mfma_f32_32x32x16_bf16 v[48:63], v[208:211], v[160:163], v[48:63]
    v_max3_f32 v248, v248, v42, v43
    v_max3_f32 v248, v248, v44, v45
    v_max3_f32 v248, v248, v46, v47
    ds_read_b128 v[208:211], v243 offset:128
    buffer_load_dwordx4 v242, s[12:15], s21 offen offset:2048 lds
    v_mfma_f32_32x32x16_bf16 v[48:63], v[212:215], v[164:167], v[48:63]
    ds_read_b128 v[212:215], v244 offset:128
    s_add_u32 s21, s21, s22
    s_add_u32 s37, s21, s23
    s_min_u32 s21, s21, s37
    s_waitcnt lgkmcnt(6)
    v_mfma_f32_32x32x16_bf16 v[48:63], v[216:219], v[168:171], v[48:63]
    ds_read_b128 v[216:219], v245 offset:128
    s_bitcmp1_b32 s25, 7
    s_cselect_b32 s37, s31, s30
    s_add_u32 s32, s32, s37
    v_mfma_f32_32x32x16_bf16 v[48:63], v[220:223], v[172:175], v[48:63]
    ds_read_b128 v[220:223], v246 offset:128
    v_mfma_f32_32x32x16_bf16 v[48:63], v[224:227], v[176:179], v[48:63]
    ds_read_b128 v[224:227], v243 offset:256
    v_mfma_f32_32x32x16_bf16 v[48:63], v[228:231], v[180:183], v[48:63]
    ds_read_b128 v[228:231], v244 offset:256
    v_mfma_f32_32x32x16_bf16 v[48:63], v[232:235], v[184:187], v[48:63]
    ds_read_b128 v[232:235], v245 offset:256
    s_bitcmp1_b32 s25, 4
    s_cselect_b32 s44, s31, s30
    v_mfma_f32_32x32x16_bf16 v[48:63], v[236:239], v[188:191], v[48:63]
    s_waitcnt vmcnt(6)
    s_barrier
    ds_read_b128 v[236:239], v246 offset:256
L_qk4b:
    s_bitcmp0_b32 s36, 4
    s_cbranch_scc1 L_qk4_inv
    s_waitcnt lgkmcnt(6)
    v_mfma_f32_32x32x16_bf16 v[64:79], v[192:195], v[144:147], 0
    v_add_u32 v243, s44, v243
    v_add_u32 v244, s44, v244
    v_add_u32 v245, s44, v245
    v_add_u32 v246, s44, v246
    ds_read_b128 v[192:195], v243 offset:0
    v_mfma_f32_32x32x16_bf16 v[64:79], v[196:199], v[148:151], v[64:79]
    ds_read_b128 v[196:199], v244 offset:0
    v_mfma_f32_32x32x16_bf16 v[64:79], v[200:203], v[152:155], v[64:79]
    v_max3_f32 v248, v248, v48, v49
    v_max3_f32 v248, v248, v50, v51
    v_max3_f32 v248, v248, v52, v53
    ds_read_b128 v[200:203], v245 offset:0
    s_bitcmp1_b32 s24, 8
    s_cselect_b32 m0, s32, s33
    s_cselect_b32 s14, s83, 0
    buffer_load_dwordx4 v240, s[12:15], s21 offen lds
    v_mfma_f32_32x32x16_bf16 v[64:79], v[204:207], v[156:159], v[64:79]
    v_max3_f32 v248, v248, v54, v55
    v_max3_f32 v248, v248, v56, v57
    v_max3_f32 v248, v248, v58, v59
    ds_read_b128 v[204:207], v246 offset:0
    buffer_load_dwordx4 v241, s[12:15], s21 offen offset:1024 lds
    v_mfma_f32_32x32x16_bf16 v[64:79], v[208:211], v[160:163], v[64:79]
    v_max3_f32 v248, v248, v60, v61
    v_max3_f32 v248, v248, v62, v63
    v_mul_f32 v252, s35, v248
    ds_read_b128 v[208:211], v243 offset:128
    buffer_load_dwordx4 v242, s[12:15], s21 offen offset:2048 lds
    v_mfma_f32_32x32x16_bf16 v[64:79], v[212:215], v[164:167], v[64:79]
    v_sub_f32 v250, v251, v252
    v_exp_f32 v250, v250
    v_fma_f32 v32, v32, s35, -v252
    ds_read_b128 v[212:215], v244 offset:128
    s_add_u32 s21, s21, s22
    s_add_u32 s37, s21, s23
    s_min_u32 s21, s21, s37
    s_waitcnt lgkmcnt(6)
    v_mfma_f32_32x32x16_bf16 v[64:79], v[216:219], v[168:171], v[64:79]
    v_fma_f32 v33, v33, s35, -v252
    v_mul_f32 v249, v250, v249
    v_exp_f32 v32, v32
    ds_read_b128 v[216:219], v245 offset:128
    s_bitcmp1_b32 s25, 8
    s_cselect_b32 s37, s31, s30
    s_add_u32 s32, s32, s37
    v_mfma_f32_32x32x16_bf16 v[64:79], v[220:223], v[172:175], v[64:79]
    v_exp_f32 v33, v33
    v_fma_f32 v34, v34, s35, -v252
    v_add_f32 v249, v249, v32
    v_fma_f32 v35, v35, s35, -v252
    ds_read_b128 v[220:223], v246 offset:128
    v_mfma_f32_32x32x16_bf16 v[64:79], v[224:227], v[176:179], v[64:79]
    v_add_f32 v249, v249, v33
    v_exp_f32 v34, v34
    v_exp_f32 v35, v35
    ds_read_b128 v[224:227], v243 offset:256
    v_mfma_f32_32x32x16_bf16 v[64:79], v[228:231], v[180:183], v[64:79]
    v_fma_f32 v36, v36, s35, -v252
    v_add_f32 v249, v249, v34
    v_fma_f32 v37, v37, s35, -v252
    v_add_f32 v249, v249, v35
    ds_read_b128 v[228:231], v244 offset:256
    v_mfma_f32_32x32x16_bf16 v[64:79], v[232:235], v[184:187], v[64:79]
    v_exp_f32 v36, v36
    v_exp_f32 v37, v37
    v_fma_f32 v38, v38, s35, -v252
    ds_read_b128 v[232:235], v245 offset:256
    s_bitcmp1_b32 s25, 5
    s_cselect_b32 s44, s31, s30
    v_mfma_f32_32x32x16_bf16 v[64:79], v[236:239], v[188:191], v[64:79]
    s_waitcnt vmcnt(6)
    s_barrier
    v_add_f32 v249, v249, v36
    v_fma_f32 v39, v39, s35, -v252
    v_add_f32 v249, v249, v37
    v_exp_f32 v38, v38
    ds_read_b128 v[236:239], v246 offset:256
L_qk5b:
    s_bitcmp0_b32 s36, 5
    s_cbranch_scc1 L_qk5_inv
    s_waitcnt lgkmcnt(6)
    v_mfma_f32_32x32x16_bf16 v[80:95], v[192:195], v[144:147], 0
    v_add_u32 v243, s44, v243
    v_add_u32 v244, s44, v244
    v_add_u32 v245, s44, v245
    v_add_u32 v246, s44, v246
    ds_read_b128 v[192:195], v243 offset:0
    v_mfma_f32_32x32x16_bf16 v[80:95], v[196:199], v[148:151], v[80:95]
    v_exp_f32 v39, v39
    v_fma_f32 v40, v40, s35, -v252
    v_add_f32 v249, v249, v38
    v_fma_f32 v41, v41, s35, -v252
    ds_read_b128 v[196:199], v244 offset:0
    v_mfma_f32_32x32x16_bf16 v[80:95], v[200:203], v[152:155], v[80:95]
    v_max3_f32 v248, v248, v64, v65
    v_max3_f32 v248, v248, v66, v67
    v_max3_f32 v248, v248, v68, v69
    v_add_f32 v249, v249, v39
    ds_read_b128 v[200:203], v245 offset:0
    s_bitcmp1_b32 s24, 9
    s_cselect_b32 m0, s32, s33
    s_cselect_b32 s14, s83, 0
    buffer_load_dwordx4 v240, s[12:15], s21 offen lds
    v_mfma_f32_32x32x16_bf16 v[80:95], v[204:207], v[156:159], v[80:95]
    v_max3_f32 v248, v248, v70, v71
    v_max3_f32 v248, v248, v72, v73
    v_max3_f32 v248, v248, v74, v75
    v_exp_f32 v40, v40
    ds_read_b128 v[204:207], v246 offset:0
    buffer_load_dwordx4 v241, s[12:15], s21 offen offset:1024 lds
    v_mfma_f32_32x32x16_bf16 v[80:95], v[208:211], v[160:163], v[80:95]
    v_max3_f32 v248, v248, v76, v77
    v_max3_f32 v248, v248, v78, v79
    v_mul_f32 v253, s35, v248
    v_exp_f32 v41, v41
    ds_read_b128 v[208:211], v243 offset:128
    buffer_load_dwordx4 v242, s[12:15], s21 offen offset:2048 lds
    v_mfma_f32_32x32x16_bf16 v[80:95], v[212:215], v[164:167], v[80:95]
    v_fma_f32 v42, v42, s35, -v252
    v_add_f32 v249, v249, v40
    v_fma_f32 v43, v43, s35, -v252
    v_add_f32 v249, v249, v41
    ds_read_b128 v[212:215], v244 offset:128
    s_add_u32 s21, s21, s22
    s_add_u32 s37, s21, s23
    s_min_u32 s21, s21, s37
    s_waitcnt lgkmcnt(6)
    v_mfma_f32_32x32x16_bf16 v[80:95], v[216:219], v[168:171], v[80:95]
    v_exp_f32 v42, v42
    v_exp_f32 v43, v43
    v_fma_f32 v44, v44, s35, -v252
    ds_read_b128 v[216:219], v245 offset:128
    s_bitcmp1_b32 s25, 9
    s_cselect_b32 s37, s31, s30
    s_add_u32 s32, s32, s37
    v_mfma_f32_32x32x16_bf16 v[80:95], v[220:223], v[172:175], v[80:95]
    v_add_f32 v249, v249, v42
    v_fma_f32 v45, v45, s35, -v252
    v_add_f32 v249, v249, v43
    v_exp_f32 v44, v44
    ds_read_b128 v[220:223], v246 offset:128
    v_mfma_f32_32x32x16_bf16 v[80:95], v[224:227], v[176:179], v[80:95]
    v_exp_f32 v45, v45
    v_fma_f32 v46, v46, s35, -v252
    v_add_f32 v249, v249, v44
    v_fma_f32 v47, v47, s35, -v252
    ds_read_b128 v[224:227], v243 offset:256
    v_mfma_f32_32x32x16_bf16 v[80:95], v[228:231], v[180:183], v[80:95]
    v_add_f32 v249, v249, v45
    v_exp_f32 v46, v46
    ds_read_b128 v[228:231], v244 offset:256
    v_mfma_f32_32x32x16_bf16 v[80:95], v[232:235], v[184:187], v[80:95]
    v_exp_f32 v47, v47
    v_add_f32 v249, v249, v46
    v_add_f32 v249, v249, v47
    v_fma_f32 v48, v48, s35, -v252
    ds_read_b128 v[232:235], v245 offset:256
    s_bitcmp1_b32 s25, 6
    s_cselect_b32 s44, s31, s30
    v_mfma_f32_32x32x16_bf16 v[80:95], v[236:239], v[188:191], v[80:95]
    s_waitcnt vmcnt(6)
    s_barrier
    v_fma_f32 v49, v49, s35, -v252
    v_exp_f32 v48, v48
    v_exp_f32 v49, v49
    ds_read_b128 v[236:239], v246 offset:256
L_qk6b:
    s_bitcmp0_b32 s36, 6
    s_cbranch_scc1 L_qk6_inv
    s_waitcnt lgkmcnt(6)
    v_mfma_f32_32x32x16_bf16 v[96:111], v[192:195], v[144:147], 0
    v_add_u32 v243, s44, v243
    v_add_u32 v244, s44, v244
    v_add_u32 v245, s44, v245
    v_add_u32 v246, s44, v246
    v_fma_f32 v50, v50, s35, -v252
    ds_read_b128 v[192:195], v243 offset:0
    v_mfma_f32_32x32x16_bf16 v[96:111], v[196:199], v[148:151], v[96:111]
    v_add_f32 v249, v249, v48
    v_fma_f32 v51, v51, s35, -v252
    v_add_f32 v249, v249, v49
    ds_read_b128 v[196:199], v244 offset:0
    v_mfma_f32_32x32x16_bf16 v[96:111], v[200:203], v[152:155], v[96:111]
    v_max3_f32 v248, v248, v80, v81
    v_max3_f32 v248, v248, v82, v83
    v_exp_f32 v50, v50
    ds_read_b128 v[200:203], v245 offset:0
    s_bitcmp1_b32 s24, 10
    s_cselect_b32 m0, s32, s33
    s_cselect_b32 s14, s83, 0
    buffer_load_dwordx4 v240, s[12:15], s21 offen lds
    v_mfma_f32_32x32x16_bf16 v[96:111], v[204:207], v[156:159], v[96:111]
    v_max3_f32 v248, v248, v84, v85
    v_max3_f32 v248, v248, v86, v87
    v_max3_f32 v248, v248, v88, v89
    v_exp_f32 v51, v51
    ds_read_b128 v[204:207], v246 offset:0
    buffer_load_dwordx4 v241, s[12:15], s21 offen offset:1024 lds
    v_mfma_f32_32x32x16_bf16 v[96:111], v[208:211], v[160:163], v[96:111]
    v_max3_f32 v248, v248, v90, v91
    v_max3_f32 v248, v248, v92, v93
    v_max3_f32 v248, v248, v94, v95
    v_fma_f32 v52, v52, s35, -v252
    v_add_f32 v249, v249, v50
    ds_read_b128 v[208:211], v243 offset:128
    buffer_load_dwordx4 v242, s[12:15], s21 offen offset:2048 lds
    v_mfma_f32_32x32x16_bf16 v[96:111], v[212:215], v[164:167], v[96:111]
    v_fma_f32 v53, v53, s35, -v252
    v_add_f32 v249, v249, v51
    v_exp_f32 v52, v52
    ds_read_b128 v[212:215], v244 offset:128
    s_add_u32 s21, s21, s22
    s_add_u32 s37, s21, s23
    s_min_u32 s21, s21, s37
    s_waitcnt lgkmcnt(6)
    v_mfma_f32_32x32x16_bf16 v[96:111], v[216:219], v[168:171], v[96:111]
    v_exp_f32 v53, v53
    v_fma_f32 v54, v54, s35, -v252
    v_add_f32 v249, v249, v52
    v_fma_f32 v55, v55, s35, -v252
    ds_read_b128 v[216:219], v245 offset:128
    s_bitcmp1_b32 s25, 10
    s_cselect_b32 s37, s31, s30
    s_add_u32 s32, s32, s37
    v_mfma_f32_32x32x16_bf16 v[96:111], v[220:223], v[172:175], v[96:111]
    v_add_f32 v249, v249, v53
    v_exp_f32 v54, v54
    v_exp_f32 v55, v55
    ds_read_b128 v[220:223], v246 offset:128
    v_mfma_f32_32x32x16_bf16 v[96:111], v[224:227], v[176:179], v[96:111]
    v_fma_f32 v56, v56, s35, -v252
    v_add_f32 v249, v249, v54
    v_fma_f32 v57, v57, s35, -v252
    v_add_f32 v249, v249, v55
    ds_read_b128 v[224:227], v243 offset:256
    v_mfma_f32_32x32x16_bf16 v[96:111], v[228:231], v[180:183], v[96:111]
    v_exp_f32 v56, v56
    v_exp_f32 v57, v57
    v_fma_f32 v58, v58, s35, -v252
    ds_read_b128 v[228:231], v244 offset:256
    v_mfma_f32_32x32x16_bf16 v[96:111], v[232:235], v[184:187], v[96:111]
    v_add_f32 v249, v249, v56
    v_fma_f32 v59, v59, s35, -v252
    v_add_f32 v249, v249, v57
    v_exp_f32 v58, v58
    ds_read_b128 v[232:235], v245 offset:256
    s_bitcmp1_b32 s25, 7
    s_cselect_b32 s44, s31, s30
    v_mfma_f32_32x32x16_bf16 v[96:111], v[236:239], v[188:191], v[96:111]
    s_waitcnt vmcnt(6)
    s_barrier
    v_exp_f32 v59, v59
    v_fma_f32 v60, v60, s35, -v252
    v_add_f32 v249, v249, v58
    v_fma_f32 v61, v61, s35, -v252
    ds_read_b128 v[236:239], v246 offset:256
L_qk7b:
    s_bitcmp0_b32 s36, 7
    s_cbranch_scc1 L_qk7_inv
    s_waitcnt lgkmcnt(6)
    v_mfma_f32_32x32x16_bf16 v[112:127], v[192:195], v[144:147], 0
    v_add_u32 v243, s44, v243
    v_add_u32 v244, s44, v244
    v_add_u32 v245, s44, v245
    v_add_u32 v246, s44, v246
    ds_read_b128 v[192:195], v243 offset:0
    v_mfma_f32_32x32x16_bf16 v[112:127], v[196:199], v[148:151], v[112:127]
    v_add_f32 v249, v249, v59
    v_exp_f32 v60, v60
    v_exp_f32 v61, v61
    ds_read_b128 v[196:199], v244 offset:0
    v_mfma_f32_32x32x16_bf16 v[112:127], v[200:203], v[152:155], v[112:127]
    v_max3_f32 v248, v248, v96, v97
    v_max3_f32 v248, v248, v98, v99
    v_fma_f32 v62, v62, s35, -v252
    v_add_f32 v249, v249, v60
    v_fma_f32 v63, v63, s35, -v252
    ds_read_b128 v[200:203], v245 offset:0
    s_bitcmp1_b32 s24, 11
    s_cselect_b32 m0, s32, s33
    s_cselect_b32 s14, s83, 0
    buffer_load_dwordx4 v240, s[12:15], s21 offen lds
    v_mfma_f32_32x32x16_bf16 v[112:127], v[204:207], v[156:159], v[112:127]
    v_max3_f32 v248, v248, v100, v101
    v_max3_f32 v248, v248, v102, v103
    v_max3_f32 v248, v248, v104, v105
    v_add_f32 v249, v249, v61
    ds_read_b128 v[204:207], v246 offset:0
    buffer_load_dwordx4 v241, s[12:15], s21 offen offset:1024 lds
    v_mfma_f32_32x32x16_bf16 v[112:127], v[208:211], v[160:163], v[112:127]
    v_max3_f32 v248, v248, v106, v107
    v_max3_f32 v248, v248, v108, v109
    v_max3_f32 v248, v248, v110, v111
    v_exp_f32 v62, v62
    ds_read_b128 v[208:211], v243 offset:128
    buffer_load_dwordx4 v242, s[12:15], s21 offen offset:2048 lds
    v_mfma_f32_32x32x16_bf16 v[112:127], v[212:215], v[164:167], v[112:127]
    v_exp_f32 v63, v63
    v_add_f32 v249, v249, v62
    v_add_f32 v249, v249, v63
    v_sub_f32 v250, v252, v253
    ds_read_b128 v[212:215], v244 offset:128
    s_add_u32 s21, s21, s22
    s_add_u32 s37, s21, s23
    s_min_u32 s21, s21, s37
    s_waitcnt lgkmcnt(6)
    v_mfma_f32_32x32x16_bf16 v[112:127], v[216:219], v[168:171], v[112:127]
    v_exp_f32 v250, v250
    v_fma_f32 v64, v64, s35, -v253
    v_fma_f32 v65, v65, s35, -v253
    v_mul_f32 v249, v250, v249
    ds_read_b128 v[216:219], v245 offset:128
    s_bitcmp1_b32 s25, 11
    s_cselect_b32 s37, s31, s30
    s_add_u32 s32, s32, s37
    v_mfma_f32_32x32x16_bf16 v[112:127], v[220:223], v[172:175], v[112:127]
    v_exp_f32 v64, v64
    v_exp_f32 v65, v65
    ds_read_b128 v[220:223], v246 offset:128
    v_mfma_f32_32x32x16_bf16 v[112:127], v[224:227], v[176:179], v[112:127]
    v_fma_f32 v66, v66, s35, -v253
    v_add_f32 v249, v249, v64
    v_fma_f32 v67, v67, s35, -v253
    v_add_f32 v249, v249, v65
    ds_read_b128 v[224:227], v243 offset:256
    v_mfma_f32_32x32x16_bf16 v[112:127], v[228:231], v[180:183], v[112:127]
    v_exp_f32 v66, v66
    v_exp_f32 v67, v67
    v_fma_f32 v68, v68, s35, -v253
    ds_read_b128 v[228:231], v244 offset:256
    v_mfma_f32_32x32x16_bf16 v[112:127], v[232:235], v[184:187], v[112:127]
    v_add_f32 v249, v249, v66
    v_fma_f32 v69, v69, s35, -v253
    v_add_f32 v249, v249, v67
    v_exp_f32 v68, v68
    ds_read_b128 v[232:235], v245 offset:256
    v_mfma_f32_32x32x16_bf16 v[112:127], v[236:239], v[188:191], v[112:127]
    s_waitcnt vmcnt(6)
    s_barrier
    v_exp_f32 v69, v69
    v_fma_f32 v70, v70, s35, -v253
    v_add_f32 v249, v249, v68
    v_fma_f32 v71, v71, s35, -v253
    ds_read_b128 v[236:239], v246 offset:256
L_qk8b:
    s_bitcmp0_b32 s36, 8
    s_cbranch_scc1 L_qk8_inv
    s_waitcnt lgkmcnt(6)
    v_mfma_f32_32x32x16_bf16 v[128:143], v[192:195], v[144:147], v[128:143]
    v_add_u32 v243, s34, v247
    v_xor_b32 v244, 64, v243
    v_xor_b32 v245, 32, v243
    v_xor_b32 v246, 0x60, v243
    v_mfma_f32_32x32x16_bf16 v[128:143], v[196:199], v[148:151], v[128:143]
    v_add_f32 v249, v249, v69
    v_exp_f32 v70, v70
    v_exp_f32 v71, v71
    s_waitcnt lgkmcnt(0)
    v_mfma_f32_32x32x16_bf16 v[128:143], v[200:203], v[152:155], v[128:143]
    v_max3_f32 v248, v248, v112, v113
    v_max3_f32 v248, v248, v114, v115
    v_fma_f32 v72, v72, s35, -v253
    v_add_f32 v249, v249, v70
    v_fma_f32 v73, v73, s35, -v253
    ds_read_b64_tr_b16 v[192:193], v243 offset:12288
    ds_read_b64_tr_b16 v[194:195], v245 offset:15360
    s_bitcmp1_b32 s24, 12
    s_cselect_b32 m0, s32, s33
    s_cselect_b32 s14, s83, 0
    buffer_load_dwordx4 v240, s[12:15], s21 offen lds
    v_mfma_f32_32x32x16_bf16 v[128:143], v[204:207], v[156:159], v[128:143]
    v_max3_f32 v248, v248, v116, v117
    v_max3_f32 v248, v248, v118, v119
    v_max3_f32 v248, v248, v120, v121
    v_add_f32 v249, v249, v71
    ds_read_b64_tr_b16 v[196:197], v243 offset:18432
    ds_read_b64_tr_b16 v[198:199], v245 offset:21504
    buffer_load_dwordx4 v241, s[12:15], s21 offen offset:1024 lds
    v_mfma_f32_32x32x16_bf16 v[128:143], v[208:211], v[160:163], v[128:143]
    v_max3_f32 v248, v248, v122, v123
    v_max3_f32 v248, v248, v124, v125
    v_max3_f32 v248, v248, v126, v127
    v_exp_f32 v72, v72
    ds_read_b64_tr_b16 v[200:201], v244 offset:12288
    ds_read_b64_tr_b16 v[202:203], v246 offset:15360
    buffer_load_dwordx4 v242, s[12:15], s21 offen offset:2048 lds
    v_mfma_f32_32x32x16_bf16 v[128:143], v[212:215], v[164:167], v[128:143]
    v_exp_f32 v73, v73
    v_fma_f32 v74, v74, s35, -v253
    v_add_f32 v249, v249, v72
    v_fma_f32 v75, v75, s35, -v253
    ds_read_b64_tr_b16 v[204:205], v244 offset:18432
    ds_read_b64_tr_b16 v[206:207], v246 offset:21504
    s_add_u32 s21, s21, s22
    s_add_u32 s37, s21, s23
    s_min_u32 s21, s21, s37
    v_mfma_f32_32x32x16_bf16 v[128:143], v[216:219], v[168:171], v[128:143]
    v_add_f32 v249, v249, v73
    v_exp_f32 v74, v74
    v_exp_f32 v75, v75
    ds_read_b64_tr_b16 v[208:209], v243 offset:12416
    ds_read_b64_tr_b16 v[210:211], v245 offset:15488
    s_bitcmp1_b32 s25, 12
    s_cselect_b32 s37, s31, s30
    s_add_u32 s32, s32, s37
    v_mfma_f32_32x32x16_bf16 v[128:143], v[220:223], v[172:175], v[128:143]
    v_fma_f32 v76, v76, s35, -v253
    v_add_f32 v249, v249, v74
    v_fma_f32 v77, v77, s35, -v253
    v_add_f32 v249, v249, v75
    ds_read_b64_tr_b16 v[212:213], v243 offset:18560
    ds_read_b64_tr_b16 v[214:215], v245 offset:21632
    v_mfma_f32_32x32x16_bf16 v[128:143], v[224:227], v[176:179], v[128:143]
    v_exp_f32 v76, v76
    v_exp_f32 v77, v77
    v_fma_f32 v78, v78, s35, -v253
    ds_read_b64_tr_b16 v[216:217], v244 offset:12416
    ds_read_b64_tr_b16 v[218:219], v246 offset:15488
    v_mfma_f32_32x32x16_bf16 v[128:143], v[228:231], v[180:183], v[128:143]
    v_add_f32 v249, v249, v76
    v_fma_f32 v79, v79, s35, -v253
    v_add_f32 v249, v249, v77
    v_exp_f32 v78, v78
    v_mfma_f32_32x32x16_bf16 v[128:143], v[232:235], v[184:187], v[128:143]
    v_exp_f32 v79, v79
    v_add_f32 v249, v249, v78
    v_add_f32 v249, v249, v79
    v_mfma_f32_32x32x16_bf16 v[128:143], v[236:239], v[188:191], v[128:143]
    s_branch L_pv0
L_qk1_inv:
    s_waitcnt lgkmcnt(0)
    v_mov_b32 v16, 0xf149f2ca
    v_mov_b32 v17, 0xf149f2ca
    v_mov_b32 v18, 0xf149f2ca
    v_mov_b32 v19, 0xf149f2ca
    v_mov_b32 v20, 0xf149f2ca
    v_mov_b32 v21, 0xf149f2ca
    v_mov_b32 v22, 0xf149f2ca
    v_mov_b32 v23, 0xf149f2ca
    v_mov_b32 v24, 0xf149f2ca
    v_mov_b32 v25, 0xf149f2ca
    v_mov_b32 v26, 0xf149f2ca
    v_mov_b32 v27, 0xf149f2ca
    v_mov_b32 v28, 0xf149f2ca
    v_mov_b32 v29, 0xf149f2ca
    v_mov_b32 v30, 0xf149f2ca
    v_mov_b32 v31, 0xf149f2ca
    v_add_u32 v243, s44, v243
    v_add_u32 v244, s44, v244
    v_add_u32 v245, s44, v245
    v_add_u32 v246, s44, v246
    s_bitcmp1_b32 s29, 5
    s_cselect_b64 s[12:13], s[26:27], s[12:13]
    s_cselect_b32 s21, s28, s21
    v_max3_f32 v248, v248, v0, v1
    v_max3_f32 v248, v248, v2, v3
    s_bitcmp1_b32 s24, 5
    s_cselect_b32 m0, s32, s33
    s_cselect_b32 s14, s83, 0
    buffer_load_dwordx4 v240, s[12:15], s21 offen lds
    v_max3_f32 v248, v248, v4, v5
    v_max3_f32 v248, v248, v6, v7
    v_max3_f32 v248, v248, v8, v9
    buffer_load_dwordx4 v241, s[12:15], s21 offen offset:1024 lds
    v_max3_f32 v248, v248, v10, v11
    v_max3_f32 v248, v248, v12, v13
    v_max3_f32 v248, v248, v14, v15
    buffer_load_dwordx4 v242, s[12:15], s21 offen offset:2048 lds
    s_add_u32 s21, s21, s22
    s_add_u32 s37, s21, s23
    s_min_u32 s21, s21, s37
    s_bitcmp1_b32 s25, 5
    s_cselect_b32 s37, s31, s30
    s_add_u32 s32, s32, s37
    s_bitcmp1_b32 s25, 2
    s_cselect_b32 s44, s31, s30
    s_waitcnt vmcnt(6)
    s_barrier
L_qk2_inv:
    s_waitcnt lgkmcnt(0)
    v_mov_b32 v32, 0xf149f2ca
    v_mov_b32 v33, 0xf149f2ca
    v_mov_b32 v34, 0xf149f2ca
    v_mov_b32 v35, 0xf149f2ca
    v_mov_b32 v36, 0xf149f2ca
    v_mov_b32 v37, 0xf149f2ca
    v_mov_b32 v38, 0xf149f2ca
    v_mov_b32 v39, 0xf149f2ca
    v_mov_b32 v40, 0xf149f2ca
    v_mov_b32 v41, 0xf149f2ca
    v_mov_b32 v42, 0xf149f2ca
    v_mov_b32 v43, 0xf149f2ca
    v_mov_b32 v44, 0xf149f2ca
    v_mov_b32 v45, 0xf149f2ca
    v_mov_b32 v46, 0xf149f2ca
    v_mov_b32 v47, 0xf149f2ca
    v_add_u32 v243, s44, v243
    v_add_u32 v244, s44, v244
    v_add_u32 v245, s44, v245
    v_add_u32 v246, s44, v246
    v_max3_f32 v248, v248, v16, v17
    v_max3_f32 v248, v248, v18, v19
    v_max3_f32 v248, v248, v20, v21
    s_bitcmp1_b32 s24, 6
    s_cselect_b32 m0, s32, s33
    s_cselect_b32 s14, s83, 0
    buffer_load_dwordx4 v240, s[12:15], s21 offen lds
    v_max3_f32 v248, v248, v22, v23
    v_max3_f32 v248, v248, v24, v25
    v_max3_f32 v248, v248, v26, v27
    buffer_load_dwordx4 v241, s[12:15], s21 offen offset:1024 lds
    v_max3_f32 v248, v248, v28, v29
    v_max3_f32 v248, v248, v30, v31
    v_mul_f32 v251, s35, v248
    buffer_load_dwordx4 v242, s[12:15], s21 offen offset:2048 lds
    v_fma_f32 v0, v0, s35, -v251
    v_fma_f32 v1, v1, s35, -v251
    v_exp_f32 v0, v0
    v_exp_f32 v1, v1
    v_fma_f32 v2, v2, s35, -v251
    v_add_f32 v249, v249, v0
    v_fma_f32 v3, v3, s35, -v251
    v_add_f32 v249, v249, v1
    v_exp_f32 v2, v2
    v_exp_f32 v3, v3
    v_fma_f32 v4, v4, s35, -v251
    v_add_f32 v249, v249, v2
    v_fma_f32 v5, v5, s35, -v251
    v_add_f32 v249, v249, v3
    v_exp_f32 v4, v4
    s_add_u32 s21, s21, s22
    s_add_u32 s37, s21, s23
    s_min_u32 s21, s21, s37
    v_exp_f32 v5, v5
    v_fma_f32 v6, v6, s35, -v251
    v_add_f32 v249, v249, v4
    v_fma_f32 v7, v7, s35, -v251
    v_add_f32 v249, v249, v5
    v_exp_f32 v6, v6
    v_exp_f32 v7, v7
    v_fma_f32 v8, v8, s35, -v251
    v_add_f32 v249, v249, v6
    v_fma_f32 v9, v9, s35, -v251
    v_add_f32 v249, v249, v7
    v_exp_f32 v8, v8
    v_exp_f32 v9, v9
    v_fma_f32 v10, v10, s35, -v251
    v_add_f32 v249, v249, v8
    v_fma_f32 v11, v11, s35, -v251
    v_add_f32 v249, v249, v9
    s_bitcmp1_b32 s25, 6
    s_cselect_b32 s37, s31, s30
    s_add_u32 s32, s32, s37
    v_exp_f32 v10, v10
    v_exp_f32 v11, v11
    v_fma_f32 v12, v12, s35, -v251
    v_add_f32 v249, v249, v10
    v_fma_f32 v13, v13, s35, -v251
    v_add_f32 v249, v249, v11
    v_exp_f32 v12, v12
    v_exp_f32 v13, v13
    v_fma_f32 v14, v14, s35, -v251
    v_add_f32 v249, v249, v12
    v_fma_f32 v15, v15, s35, -v251
    v_add_f32 v249, v249, v13
    v_exp_f32 v14, v14
    v_exp_f32 v15, v15
    v_add_f32 v249, v249, v14
    v_add_f32 v249, v249, v15
    v_fma_f32 v16, v16, s35, -v251
    v_fma_f32 v17, v17, s35, -v251
    v_exp_f32 v16, v16
    v_exp_f32 v17, v17
    v_fma_f32 v18, v18, s35, -v251
    v_add_f32 v249, v249, v16
    v_fma_f32 v19, v19, s35, -v251
    v_add_f32 v249, v249, v17
    v_exp_f32 v18, v18
    v_exp_f32 v19, v19
    v_fma_f32 v20, v20, s35, -v251
    v_add_f32 v249, v249, v18
    v_fma_f32 v21, v21, s35, -v251
    v_add_f32 v249, v249, v19
    v_exp_f32 v20, v20
    s_nop 0
    v_exp_f32 v21, v21
    v_fma_f32 v22, v22, s35, -v251
    v_add_f32 v249, v249, v20
    v_fma_f32 v23, v23, s35, -v251
    v_add_f32 v249, v249, v21
    v_exp_f32 v22, v22
    v_exp_f32 v23, v23
    v_fma_f32 v24, v24, s35, -v251
    v_add_f32 v249, v249, v22
    v_fma_f32 v25, v25, s35, -v251
    v_add_f32 v249, v249, v23
    v_exp_f32 v24, v24
    v_exp_f32 v25, v25
    v_fma_f32 v26, v26, s35, -v251
    v_add_f32 v249, v249, v24
    v_fma_f32 v27, v27, s35, -v251
    v_add_f32 v249, v249, v25
    v_exp_f32 v26, v26
    v_exp_f32 v27, v27
    v_fma_f32 v28, v28, s35, -v251
    v_add_f32 v249, v249, v26
    v_fma_f32 v29, v29, s35, -v251
    v_add_f32 v249, v249, v27
    v_exp_f32 v28, v28
    v_exp_f32 v29, v29
    v_fma_f32 v30, v30, s35, -v251
    v_add_f32 v249, v249, v28
    v_fma_f32 v31, v31, s35, -v251
    v_add_f32 v249, v249, v29
    v_exp_f32 v30, v30
    v_exp_f32 v31, v31
    v_add_f32 v249, v249, v30
    v_add_f32 v249, v249, v31
    s_bitcmp1_b32 s25, 3
    s_cselect_b32 s44, s31, s30
    s_waitcnt vmcnt(6)
    s_barrier
L_qk3_inv:
    s_waitcnt lgkmcnt(0)
    v_mov_b32 v48, 0xf149f2ca
    v_mov_b32 v49, 0xf149f2ca
    v_mov_b32 v50, 0xf149f2ca
    v_mov_b32 v51, 0xf149f2ca
    v_mov_b32 v52, 0xf149f2ca
    v_mov_b32 v53, 0xf149f2ca
    v_mov_b32 v54, 0xf149f2ca
    v_mov_b32 v55, 0xf149f2ca
    v_mov_b32 v56, 0xf149f2ca
    v_mov_b32 v57, 0xf149f2ca
    v_mov_b32 v58, 0xf149f2ca
    v_mov_b32 v59, 0xf149f2ca
    v_mov_b32 v60, 0xf149f2ca
    v_mov_b32 v61, 0xf149f2ca
    v_mov_b32 v62, 0xf149f2ca
    v_mov_b32 v63, 0xf149f2ca
    v_add_u32 v243, s44, v243
    v_add_u32 v244, s44, v244
    v_add_u32 v245, s44, v245
    v_add_u32 v246, s44, v246
    v_max3_f32 v248, v248, v32, v33
    v_max3_f32 v248, v248, v34, v35
    s_bitcmp1_b32 s24, 7
    s_cselect_b32 m0, s32, s33
    s_cselect_b32 s14, s83, 0
    buffer_load_dwordx4 v240, s[12:15], s21 offen lds
    v_max3_f32 v248, v248, v36, v37
    v_max3_f32 v248, v248, v38, v39
    v_max3_f32 v248, v248, v40, v41
    buffer_load_dwordx4 v241, s[12:15], s21 offen offset:1024 lds
    v_max3_f32 v248, v248, v42, v43
    v_max3_f32 v248, v248, v44, v45
    v_max3_f32 v248, v248, v46, v47
    buffer_load_dwordx4 v242, s[12:15], s21 offen offset:2048 lds
    s_add_u32 s21, s21, s22
    s_add_u32 s37, s21, s23
    s_min_u32 s21, s21, s37
    s_bitcmp1_b32 s25, 7
    s_cselect_b32 s37, s31, s30
    s_add_u32 s32, s32, s37
    s_bitcmp1_b32 s25, 4
    s_cselect_b32 s44, s31, s30
    s_waitcnt vmcnt(6)
    s_barrier
L_qk4_inv:
    s_waitcnt lgkmcnt(0)
    v_mov_b32 v64, 0xf149f2ca
    v_mov_b32 v65, 0xf149f2ca
    v_mov_b32 v66, 0xf149f2ca
    v_mov_b32 v67, 0xf149f2ca
    v_mov_b32 v68, 0xf149f2ca
    v_mov_b32 v69, 0xf149f2ca
    v_mov_b32 v70, 0xf149f2ca
    v_mov_b32 v71, 0xf149f2ca
    v_mov_b32 v72, 0xf149f2ca
    v_mov_b32 v73, 0xf149f2ca
    v_mov_b32 v74, 0xf149f2ca
    v_mov_b32 v75, 0xf149f2ca
    v_mov_b32 v76, 0xf149f2ca
    v_mov_b32 v77, 0xf149f2ca
    v_mov_b32 v78, 0xf149f2ca
    v_mov_b32 v79, 0xf149f2ca
    v_add_u32 v243, s44, v243
    v_add_u32 v244, s44, v244
    v_add_u32 v245, s44, v245
    v_add_u32 v246, s44, v246
    v_max3_f32 v248, v248, v48, v49
    v_max3_f32 v248, v248, v50, v51
    v_max3_f32 v248, v248, v52, v53
    s_bitcmp1_b32 s24, 8
    s_cselect_b32 m0, s32, s33
    s_cselect_b32 s14, s83, 0
    buffer_load_dwordx4 v240, s[12:15], s21 offen lds
    v_max3_f32 v248, v248, v54, v55
    v_max3_f32 v248, v248, v56, v57
    v_max3_f32 v248, v248, v58, v59
    buffer_load_dwordx4 v241, s[12:15], s21 offen offset:1024 lds
    v_max3_f32 v248, v248, v60, v61
    v_max3_f32 v248, v248, v62, v63
    v_mul_f32 v252, s35, v248
    buffer_load_dwordx4 v242, s[12:15], s21 offen offset:2048 lds
    v_sub_f32 v250, v251, v252
    v_exp_f32 v250, v250
    v_fma_f32 v32, v32, s35, -v252
    s_add_u32 s21, s21, s22
    s_add_u32 s37, s21, s23
    s_min_u32 s21, s21, s37
    v_fma_f32 v33, v33, s35, -v252
    v_mul_f32 v249, v250, v249
    v_exp_f32 v32, v32
    s_bitcmp1_b32 s25, 8
    s_cselect_b32 s37, s31, s30
    s_add_u32 s32, s32, s37
    v_exp_f32 v33, v33
    v_fma_f32 v34, v34, s35, -v252
    v_add_f32 v249, v249, v32
    v_fma_f32 v35, v35, s35, -v252
    v_add_f32 v249, v249, v33
    v_exp_f32 v34, v34
    v_exp_f32 v35, v35
    s_nop 0
    v_fma_f32 v36, v36, s35, -v252
    v_add_f32 v249, v249, v34
    v_fma_f32 v37, v37, s35, -v252
    v_add_f32 v249, v249, v35
    v_exp_f32 v36, v36
    v_exp_f32 v37, v37
    v_fma_f32 v38, v38, s35, -v252
    s_bitcmp1_b32 s25, 5
    s_cselect_b32 s44, s31, s30
    s_waitcnt vmcnt(6)
    s_barrier
    v_add_f32 v249, v249, v36
    v_fma_f32 v39, v39, s35, -v252
    v_add_f32 v249, v249, v37
    v_exp_f32 v38, v38
    s_nop 0
L_qk5_inv:
    s_waitcnt lgkmcnt(0)
    v_mov_b32 v80, 0xf149f2ca
    v_mov_b32 v81, 0xf149f2ca
    v_mov_b32 v82, 0xf149f2ca
    v_mov_b32 v83, 0xf149f2ca
    v_mov_b32 v84, 0xf149f2ca
    v_mov_b32 v85, 0xf149f2ca
    v_mov_b32 v86, 0xf149f2ca
    v_mov_b32 v87, 0xf149f2ca
    v_mov_b32 v88, 0xf149f2ca
    v_mov_b32 v89, 0xf149f2ca
    v_mov_b32 v90, 0xf149f2ca
    v_mov_b32 v91, 0xf149f2ca
    v_mov_b32 v92, 0xf149f2ca
    v_mov_b32 v93, 0xf149f2ca
    v_mov_b32 v94, 0xf149f2ca
    v_mov_b32 v95, 0xf149f2ca
    v_add_u32 v243, s44, v243
    v_add_u32 v244, s44, v244
    v_add_u32 v245, s44, v245
    v_add_u32 v246, s44, v246
    v_exp_f32 v39, v39
    v_fma_f32 v40, v40, s35, -v252
    v_add_f32 v249, v249, v38
    v_fma_f32 v41, v41, s35, -v252
    v_max3_f32 v248, v248, v64, v65
    v_max3_f32 v248, v248, v66, v67
    v_max3_f32 v248, v248, v68, v69
    v_add_f32 v249, v249, v39
    s_bitcmp1_b32 s24, 9
    s_cselect_b32 m0, s32, s33
    s_cselect_b32 s14, s83, 0
    buffer_load_dwordx4 v240, s[12:15], s21 offen lds
    v_max3_f32 v248, v248, v70, v71
    v_max3_f32 v248, v248, v72, v73
    v_max3_f32 v248, v248, v74, v75
    v_exp_f32 v40, v40
    buffer_load_dwordx4 v241, s[12:15], s21 offen offset:1024 lds
    v_max3_f32 v248, v248, v76, v77
    v_max3_f32 v248, v248, v78, v79
    v_mul_f32 v253, s35, v248
    v_exp_f32 v41, v41
    buffer_load_dwordx4 v242, s[12:15], s21 offen offset:2048 lds
    v_fma_f32 v42, v42, s35, -v252
    v_add_f32 v249, v249, v40
    v_fma_f32 v43, v43, s35, -v252
    v_add_f32 v249, v249, v41
    s_add_u32 s21, s21, s22
    s_add_u32 s37, s21, s23
    s_min_u32 s21, s21, s37
    v_exp_f32 v42, v42
    v_exp_f32 v43, v43
    v_fma_f32 v44, v44, s35, -v252
    s_bitcmp1_b32 s25, 9
    s_cselect_b32 s37, s31, s30
    s_add_u32 s32, s32, s37
    v_add_f32 v249, v249, v42
    v_fma_f32 v45, v45, s35, -v252
    v_add_f32 v249, v249, v43
    v_exp_f32 v44, v44
    s_nop 0
    v_exp_f32 v45, v45
    v_fma_f32 v46, v46, s35, -v252
    v_add_f32 v249, v249, v44
    v_fma_f32 v47, v47, s35, -v252
    v_add_f32 v249, v249, v45
    v_exp_f32 v46, v46
    s_nop 0
    v_exp_f32 v47, v47
    v_add_f32 v249, v249, v46
    v_add_f32 v249, v249, v47
    v_fma_f32 v48, v48, s35, -v252
    s_bitcmp1_b32 s25, 6
    s_cselect_b32 s44, s31, s30
    s_waitcnt vmcnt(6)
    s_barrier
    v_fma_f32 v49, v49, s35, -v252
    v_exp_f32 v48, v48
    v_exp_f32 v49, v49
    s_nop 0
L_qk6_inv:
    s_waitcnt lgkmcnt(0)
    v_mov_b32 v96, 0xf149f2ca
    v_mov_b32 v97, 0xf149f2ca
    v_mov_b32 v98, 0xf149f2ca
    v_mov_b32 v99, 0xf149f2ca
    v_mov_b32 v100, 0xf149f2ca
    v_mov_b32 v101, 0xf149f2ca
    v_mov_b32 v102, 0xf149f2ca
    v_mov_b32 v103, 0xf149f2ca
    v_mov_b32 v104, 0xf149f2ca
    v_mov_b32 v105, 0xf149f2ca
    v_mov_b32 v106, 0xf149f2ca
    v_mov_b32 v107, 0xf149f2ca
    v_mov_b32 v108, 0xf149f2ca
    v_mov_b32 v109, 0xf149f2ca
    v_mov_b32 v110, 0xf149f2ca
    v_mov_b32 v111, 0xf149f2ca
    v_add_u32 v243, s44, v243
    v_add_u32 v244, s44, v244
    v_add_u32 v245, s44, v245
    v_add_u32 v246, s44, v246
    v_fma_f32 v50, v50, s35, -v252
    v_add_f32 v249, v249, v48
    v_fma_f32 v51, v51, s35, -v252
    v_add_f32 v249, v249, v49
    v_max3_f32 v248, v248, v80, v81
    v_max3_f32 v248, v248, v82, v83
    v_exp_f32 v50, v50
    s_bitcmp1_b32 s24, 10
    s_cselect_b32 m0, s32, s33
    s_cselect_b32 s14, s83, 0
    buffer_load_dwordx4 v240, s[12:15], s21 offen lds
    v_max3_f32 v248, v248, v84, v85
    v_max3_f32 v248, v248, v86, v87
    v_max3_f32 v248, v248, v88, v89
    v_exp_f32 v51, v51
    buffer_load_dwordx4 v241, s[12:15], s21 offen offset:1024 lds
    v_max3_f32 v248, v248, v90, v91
    v_max3_f32 v248, v248, v92, v93
    v_max3_f32 v248, v248, v94, v95
    v_fma_f32 v52, v52, s35, -v252
    v_add_f32 v249, v249, v50
    buffer_load_dwordx4 v242, s[12:15], s21 offen offset:2048 lds
    v_fma_f32 v53, v53, s35, -v252
    v_add_f32 v249, v249, v51
    v_exp_f32 v52, v52
    s_add_u32 s21, s21, s22
    s_add_u32 s37, s21, s23
    s_min_u32 s21, s21, s37
    v_exp_f32 v53, v53
    v_fma_f32 v54, v54, s35, -v252
    v_add_f32 v249, v249, v52
    v_fma_f32 v55, v55, s35, -v252
    s_bitcmp1_b32 s25, 10
    s_cselect_b32 s37, s31, s30
    s_add_u32 s32, s32, s37
    v_add_f32 v249, v249, v53
    v_exp_f32 v54, v54
    v_exp_f32 v55, v55
    s_nop 0
    v_fma_f32 v56, v56, s35, -v252
    v_add_f32 v249, v249, v54
    v_fma_f32 v57, v57, s35, -v252
    v_add_f32 v249, v249, v55
    v_exp_f32 v56, v56
    v_exp_f32 v57, v57
    v_fma_f32 v58, v58, s35, -v252
    v_add_f32 v249, v249, v56
    v_fma_f32 v59, v59, s35, -v252
    v_add_f32 v249, v249, v57
    v_exp_f32 v58, v58
    s_bitcmp1_b32 s25, 7
    s_cselect_b32 s44, s31, s30
    s_waitcnt vmcnt(6)
    s_barrier
    v_exp_f32 v59, v59
    v_fma_f32 v60, v60, s35, -v252
    v_add_f32 v249, v249, v58
    v_fma_f32 v61, v61, s35, -v252
L_qk7_inv:
    s_waitcnt lgkmcnt(0)
    v_mov_b32 v112, 0xf149f2ca
    v_mov_b32 v113, 0xf149f2ca
    v_mov_b32 v114, 0xf149f2ca
    v_mov_b32 v115, 0xf149f2ca
    v_mov_b32 v116, 0xf149f2ca
    v_mov_b32 v117, 0xf149f2ca
    v_mov_b32 v118, 0xf149f2ca
    v_mov_b32 v119, 0xf149f2ca
    v_mov_b32 v120, 0xf149f2ca
    v_mov_b32 v121, 0xf149f2ca
    v_mov_b32 v122, 0xf149f2ca
    v_mov_b32 v123, 0xf149f2ca
    v_mov_b32 v124, 0xf149f2ca
    v_mov_b32 v125, 0xf149f2ca
    v_mov_b32 v126, 0xf149f2ca
    v_mov_b32 v127, 0xf149f2ca
    v_add_u32 v243, s44, v243
    v_add_u32 v244, s44, v244
    v_add_u32 v245, s44, v245
    v_add_u32 v246, s44, v246
    v_add_f32 v249, v249, v59
    v_exp_f32 v60, v60
    v_exp_f32 v61, v61
    s_nop 0
    v_max3_f32 v248, v248, v96, v97
    v_max3_f32 v248, v248, v98, v99
    v_fma_f32 v62, v62, s35, -v252
    v_add_f32 v249, v249, v60
    v_fma_f32 v63, v63, s35, -v252
    s_bitcmp1_b32 s24, 11
    s_cselect_b32 m0, s32, s33
    s_cselect_b32 s14, s83, 0
    buffer_load_dwordx4 v240, s[12:15], s21 offen lds
    v_max3_f32 v248, v248, v100, v101
    v_max3_f32 v248, v248, v102, v103
    v_max3_f32 v248, v248, v104, v105
    v_add_f32 v249, v249, v61
    buffer_load_dwordx4 v241, s[12:15], s21 offen offset:1024 lds
    v_max3_f32 v248, v248, v106, v107
    v_max3_f32 v248, v248, v108, v109
    v_max3_f32 v248, v248, v110, v111
    v_exp_f32 v62, v62
    buffer_load_dwordx4 v242, s[12:15], s21 offen offset:2048 lds
    v_exp_f32 v63, v63
    v_add_f32 v249, v249, v62
    v_add_f32 v249, v249, v63
    v_sub_f32 v250, v252, v253
    s_add_u32 s21, s21, s22
    s_add_u32 s37, s21, s23
    s_min_u32 s21, s21, s37
    v_exp_f32 v250, v250
    v_fma_f32 v64, v64, s35, -v253
    v_fma_f32 v65, v65, s35, -v253
    v_mul_f32 v249, v250, v249
    s_bitcmp1_b32 s25, 11
    s_cselect_b32 s37, s31, s30
    s_add_u32 s32, s32, s37
    v_exp_f32 v64, v64
    v_exp_f32 v65, v65
    s_nop 0
    v_fma_f32 v66, v66, s35, -v253
    v_add_f32 v249, v249, v64
    v_fma_f32 v67, v67, s35, -v253
    v_add_f32 v249, v249, v65
    v_exp_f32 v66, v66
    v_exp_f32 v67, v67
    v_fma_f32 v68, v68, s35, -v253
    v_add_f32 v249, v249, v66
    v_fma_f32 v69, v69, s35, -v253
    v_add_f32 v249, v249, v67
    v_exp_f32 v68, v68
    s_nop 0
    s_waitcnt vmcnt(6)
    s_barrier
    v_exp_f32 v69, v69
    v_fma_f32 v70, v70, s35, -v253
    v_add_f32 v249, v249, v68
    v_fma_f32 v71, v71, s35, -v253
L_qk8_inv:
    s_waitcnt lgkmcnt(0)
    v_mov_b32 v128, 0xf149f2ca
    v_mov_b32 v129, 0xf149f2ca
    v_mov_b32 v130, 0xf149f2ca
    v_mov_b32 v131, 0xf149f2ca
    v_mov_b32 v132, 0xf149f2ca
    v_mov_b32 v133, 0xf149f2ca
    v_mov_b32 v134, 0xf149f2ca
    v_mov_b32 v135, 0xf149f2ca
    v_mov_b32 v136, 0xf149f2ca
    v_mov_b32 v137, 0xf149f2ca
    v_mov_b32 v138, 0xf149f2ca
    v_mov_b32 v139, 0xf149f2ca
    v_mov_b32 v140, 0xf149f2ca
    v_mov_b32 v141, 0xf149f2ca
    v_mov_b32 v142, 0xf149f2ca
    v_mov_b32 v143, 0xf149f2ca
    v_add_u32 v243, s34, v247
    v_xor_b32 v244, 64, v243
    v_xor_b32 v245, 32, v243
    v_xor_b32 v246, 0x60, v243
    v_add_f32 v249, v249, v69
    v_exp_f32 v70, v70
    v_exp_f32 v71, v71
    s_nop 0
    v_max3_f32 v248, v248, v112, v113
    v_max3_f32 v248, v248, v114, v115
    v_fma_f32 v72, v72, s35, -v253
    v_add_f32 v249, v249, v70
    v_fma_f32 v73, v73, s35, -v253
    ds_read_b64_tr_b16 v[192:193], v243 offset:12288
    ds_read_b64_tr_b16 v[194:195], v245 offset:15360
    s_bitcmp1_b32 s24, 12
    s_cselect_b32 m0, s32, s33
    s_cselect_b32 s14, s83, 0
    buffer_load_dwordx4 v240, s[12:15], s21 offen lds
    v_max3_f32 v248, v248, v116, v117
    v_max3_f32 v248, v248, v118, v119
    v_max3_f32 v248, v248, v120, v121
    v_add_f32 v249, v249, v71
    ds_read_b64_tr_b16 v[196:197], v243 offset:18432
    ds_read_b64_tr_b16 v[198:199], v245 offset:21504
    buffer_load_dwordx4 v241, s[12:15], s21 offen offset:1024 lds
    v_max3_f32 v248, v248, v122, v123
    v_max3_f32 v248, v248, v124, v125
    v_max3_f32 v248, v248, v126, v127
    v_exp_f32 v72, v72
    ds_read_b64_tr_b16 v[200:201], v244 offset:12288
    ds_read_b64_tr_b16 v[202:203], v246 offset:15360
    buffer_load_dwordx4 v242, s[12:15], s21 offen offset:2048 lds
    v_exp_f32 v73, v73
    v_fma_f32 v74, v74, s35, -v253
    v_add_f32 v249, v249, v72
    v_fma_f32 v75, v75, s35, -v253
    ds_read_b64_tr_b16 v[204:205], v244 offset:18432
    ds_read_b64_tr_b16 v[206:207], v246 offset:21504
    s_add_u32 s21, s21, s22
    s_add_u32 s37, s21, s23
    s_min_u32 s21, s21, s37
    v_add_f32 v249, v249, v73
    v_exp_f32 v74, v74
    v_exp_f32 v75, v75
    ds_read_b64_tr_b16 v[208:209], v243 offset:12416
    ds_read_b64_tr_b16 v[210:211], v245 offset:15488
    s_bitcmp1_b32 s25, 12
    s_cselect_b32 s37, s31, s30
    s_add_u32 s32, s32, s37
    v_fma_f32 v76, v76, s35, -v253
    v_add_f32 v249, v249, v74
    v_fma_f32 v77, v77, s35, -v253
    v_add_f32 v249, v249, v75
    ds_read_b64_tr_b16 v[212:213], v243 offset:18560
    ds_read_b64_tr_b16 v[214:215], v245 offset:21632
    v_exp_f32 v76, v76
    v_exp_f32 v77, v77
    v_fma_f32 v78, v78, s35, -v253
    ds_read_b64_tr_b16 v[216:217], v244 offset:12416
    ds_read_b64_tr_b16 v[218:219], v246 offset:15488
    v_add_f32 v249, v249, v76
    v_fma_f32 v79, v79, s35, -v253
    v_add_f32 v249, v249, v77
    v_exp_f32 v78, v78
    s_nop 0
    v_exp_f32 v79, v79
    v_add_f32 v249, v249, v78
    v_add_f32 v249, v249, v79
    s_waitcnt lgkmcnt(0)
    s_branch L_pv0
L_pv5b:
    s_cbranch_execz L_warm2
    s_bitcmp0_b32 s36, 5
    s_cbranch_scc1 L_pv5_inv
    s_waitcnt lgkmcnt(8)
    v_mfma_f32_32x32x16_bf16 v[144:159], v[24:27], v[80:83], v[144:159]
    ds_read_b64_tr_b16 v[24:25], v244 offset:12416
    ds_read_b64_tr_b16 v[26:27], v246 offset:15488
    v_fma_f32 v112, v112, s35, -v248
    v_fma_f32 v113, v113, s35, -v248
    v_exp_f32 v112, v112
    v_mfma_f32_32x32x16_bf16 v[144:159], v[28:31], v[84:87], v[144:159]
    ds_read_b64_tr_b16 v[28:29], v244 offset:18560
    ds_read_b64_tr_b16 v[30:31], v246 offset:21632
    v_exp_f32 v113, v113
    v_fma_f32 v114, v114, s35, -v248
    v_add_f32 v249, v249, v112
    v_fma_f32 v115, v115, s35, -v248
    s_waitcnt lgkmcnt(8)
    v_mfma_f32_32x32x16_bf16 v[160:175], v[8:11], v[80:83], v[160:175]
    ds_read_b64_tr_b16 v[8:9], v243 offset:12544
    ds_read_b64_tr_b16 v[10:11], v245 offset:15616
    v_add_f32 v249, v249, v113
    v_cvt_pk_bf16_f32 v112, v112, v113
    v_exp_f32 v114, v114
    s_bitcmp1_b32 s24, 18
    s_cselect_b32 m0, s32, s33
    s_cselect_b32 s14, s83, 0
    buffer_load_dwordx4 v240, s[12:15], s21 offen lds
    v_mfma_f32_32x32x16_bf16 v[160:175], v[0:3], v[84:87], v[160:175]
    ds_read_b64_tr_b16 v[0:1], v243 offset:18688
    ds_read_b64_tr_b16 v[2:3], v245 offset:21760
    v_exp_f32 v115, v115
    v_fma_f32 v116, v116, s35, -v248
    v_add_f32 v249, v249, v114
    v_fma_f32 v117, v117, s35, -v248
    buffer_load_dwordx4 v241, s[12:15], s21 offen offset:1024 lds
    s_waitcnt lgkmcnt(8)
    v_mfma_f32_32x32x16_bf16 v[176:191], v[12:15], v[80:83], v[176:191]
    ds_read_b64_tr_b16 v[12:13], v244 offset:12544
    ds_read_b64_tr_b16 v[14:15], v246 offset:15616
    v_add_f32 v249, v249, v115
    v_cvt_pk_bf16_f32 v113, v114, v115
    v_exp_f32 v116, v116
    s_bitcmp1_b32 s25, 14
    s_cselect_b32 s44, s31, s30
    buffer_load_dwordx4 v242, s[12:15], s21 offen offset:2048 lds
    v_mfma_f32_32x32x16_bf16 v[176:191], v[4:7], v[84:87], v[176:191]
    ds_read_b64_tr_b16 v[4:5], v244 offset:18688
    ds_read_b64_tr_b16 v[6:7], v246 offset:21760
    v_exp_f32 v117, v117
    v_fma_f32 v118, v118, s35, -v248
    v_add_f32 v249, v249, v116
    v_fma_f32 v119, v119, s35, -v248
    s_add_u32 s21, s21, s22
    s_add_u32 s37, s21, s23
    s_min_u32 s21, s21, s37
    s_waitcnt lgkmcnt(8)
    v_mfma_f32_32x32x16_bf16 v[192:207], v[24:27], v[80:83], v[192:207]
    v_add_u32 v243, s44, v243
    v_add_u32 v244, s44, v244
    v_add_u32 v245, s44, v245
    v_add_u32 v246, s44, v246
    v_add_f32 v249, v249, v117
    ds_read_b64_tr_b16 v[24:25], v243 offset:12288
    ds_read_b64_tr_b16 v[26:27], v245 offset:15360
    s_bitcmp1_b32 s25, 18
    s_cselect_b32 s37, s31, s30
    s_add_u32 s32, s32, s37
    v_mfma_f32_32x32x16_bf16 v[192:207], v[28:31], v[84:87], v[192:207]
    ds_read_b64_tr_b16 v[28:29], v243 offset:18432
    ds_read_b64_tr_b16 v[30:31], v245 offset:21504
    v_cvt_pk_bf16_f32 v114, v116, v117
    v_exp_f32 v118, v118
    v_exp_f32 v119, v119
    s_waitcnt lgkmcnt(8)
    v_mfma_f32_32x32x16_bf16 v[208:223], v[8:11], v[80:83], v[208:223]
    ds_read_b64_tr_b16 v[8:9], v244 offset:12288
    ds_read_b64_tr_b16 v[10:11], v246 offset:15360
    v_fma_f32 v120, v120, s35, -v248
    v_add_f32 v249, v249, v118
    v_fma_f32 v121, v121, s35, -v248
    v_add_f32 v249, v249, v119
    v_mfma_f32_32x32x16_bf16 v[208:223], v[0:3], v[84:87], v[208:223]
    ds_read_b64_tr_b16 v[0:1], v244 offset:18432
    ds_read_b64_tr_b16 v[2:3], v246 offset:21504
    v_cvt_pk_bf16_f32 v115, v118, v119
    v_exp_f32 v120, v120
    v_exp_f32 v121, v121
    s_waitcnt lgkmcnt(8)
    v_mfma_f32_32x32x16_bf16 v[224:239], v[12:15], v[80:83], v[224:239]
    ds_read_b64_tr_b16 v[12:13], v243 offset:12416
    ds_read_b64_tr_b16 v[14:15], v245 offset:15488
    v_fma_f32 v122, v122, s35, -v248
    v_add_f32 v249, v249, v120
    v_fma_f32 v123, v123, s35, -v248
    v_add_f32 v249, v249, v121
    v_cvt_pk_bf16_f32 v116, v120, v121
    v_mfma_f32_32x32x16_bf16 v[224:239], v[4:7], v[84:87], v[224:239]
    s_waitcnt vmcnt(6)
    s_barrier
    ds_read_b64_tr_b16 v[4:5], v243 offset:18560
    ds_read_b64_tr_b16 v[6:7], v245 offset:21632
    v_exp_f32 v122, v122
    v_exp_f32 v123, v123
L_pv6b:
    s_bitcmp0_b32 s36, 6
    s_cbranch_scc1 L_pv6_inv
    s_waitcnt lgkmcnt(8)
    v_mfma_f32_32x32x16_bf16 v[144:159], v[24:27], v[96:99], v[144:159]
    ds_read_b64_tr_b16 v[24:25], v244 offset:12416
    ds_read_b64_tr_b16 v[26:27], v246 offset:15488
    v_fma_f32 v124, v124, s35, -v248
    v_add_f32 v249, v249, v122
    v_fma_f32 v125, v125, s35, -v248
    v_add_f32 v249, v249, v123
    v_cvt_pk_bf16_f32 v117, v122, v123
    v_mfma_f32_32x32x16_bf16 v[144:159], v[28:31], v[100:103], v[144:159]
    ds_read_b64_tr_b16 v[28:29], v244 offset:18560
    ds_read_b64_tr_b16 v[30:31], v246 offset:21632
    v_exp_f32 v124, v124
    v_exp_f32 v125, v125
    v_fma_f32 v126, v126, s35, -v248
    s_waitcnt lgkmcnt(8)
    v_mfma_f32_32x32x16_bf16 v[160:175], v[8:11], v[96:99], v[160:175]
    ds_read_b64_tr_b16 v[8:9], v243 offset:12544
    ds_read_b64_tr_b16 v[10:11], v245 offset:15616
    v_add_f32 v249, v249, v124
    v_fma_f32 v127, v127, s35, -v248
    v_add_f32 v249, v249, v125
    v_cvt_pk_bf16_f32 v118, v124, v125
    s_bitcmp1_b32 s24, 19
    s_cselect_b32 m0, s32, s33
    s_cselect_b32 s14, s83, 0
    buffer_load_dwordx4 v240, s[12:15], s21 offen lds
    v_mfma_f32_32x32x16_bf16 v[160:175], v[0:3], v[100:103], v[160:175]
    ds_read_b64_tr_b16 v[0:1], v243 offset:18688
    ds_read_b64_tr_b16 v[2:3], v245 offset:21760
    v_exp_f32 v126, v126
    v_exp_f32 v127, v127
    v_add_f32 v249, v249, v126
    buffer_load_dwordx4 v241, s[12:15], s21 offen offset:1024 lds
    s_waitcnt lgkmcnt(8)
    v_mfma_f32_32x32x16_bf16 v[176:191], v[12:15], v[96:99], v[176:191]
    ds_read_b64_tr_b16 v[12:13], v244 offset:12544
    ds_read_b64_tr_b16 v[14:15], v246 offset:15616
    v_add_f32 v249, v249, v127
    v_cvt_pk_bf16_f32 v119, v126, v127
    v_fma_f32 v128, v128, s35, -v248
    v_fma_f32 v129, v129, s35, -v248
    s_bitcmp1_b32 s25, 15
    s_cselect_b32 s44, s31, s30
    buffer_load_dwordx4 v242, s[12:15], s21 offen offset:2048 lds
    v_mfma_f32_32x32x16_bf16 v[176:191], v[4:7], v[100:103], v[176:191]
    ds_read_b64_tr_b16 v[4:5], v244 offset:18688
    ds_read_b64_tr_b16 v[6:7], v246 offset:21760
    v_exp_f32 v128, v128
    v_exp_f32 v129, v129
    v_fma_f32 v130, v130, s35, -v248
    s_add_u32 s21, s21, s22
    s_add_u32 s37, s21, s23
    s_min_u32 s21, s21, s37
    s_waitcnt lgkmcnt(8)
    v_mfma_f32_32x32x16_bf16 v[192:207], v[24:27], v[96:99], v[192:207]
    v_add_u32 v243, s44, v243
    v_add_u32 v244, s44, v244
    v_add_u32 v245, s44, v245
    v_add_u32 v246, s44, v246
    v_add_f32 v249, v249, v128
    ds_read_b64_tr_b16 v[24:25], v243 offset:12288
    ds_read_b64_tr_b16 v[26:27], v245 offset:15360
    s_bitcmp1_b32 s25, 19
    s_cselect_b32 s37, s31, s30
    s_add_u32 s32, s32, s37
    v_mfma_f32_32x32x16_bf16 v[192:207], v[28:31], v[100:103], v[192:207]
    ds_read_b64_tr_b16 v[28:29], v243 offset:18432
    ds_read_b64_tr_b16 v[30:31], v245 offset:21504
    v_fma_f32 v131, v131, s35, -v248
    v_add_f32 v249, v249, v129
    v_cvt_pk_bf16_f32 v128, v128, v129
    v_exp_f32 v130, v130
    s_waitcnt lgkmcnt(8)
    v_mfma_f32_32x32x16_bf16 v[208:223], v[8:11], v[96:99], v[208:223]
    ds_read_b64_tr_b16 v[8:9], v244 offset:12288
    ds_read_b64_tr_b16 v[10:11], v246 offset:15360
    v_exp_f32 v131, v131
    v_fma_f32 v132, v132, s35, -v248
    v_add_f32 v249, v249, v130
    v_mfma_f32_32x32x16_bf16 v[208:223], v[0:3], v[100:103], v[208:223]
    ds_read_b64_tr_b16 v[0:1], v244 offset:18432
    ds_read_b64_tr_b16 v[2:3], v246 offset:21504
    v_fma_f32 v133, v133, s35, -v248
    v_add_f32 v249, v249, v131
    v_cvt_pk_bf16_f32 v129, v130, v131
    v_exp_f32 v132, v132
    s_waitcnt lgkmcnt(8)
    v_mfma_f32_32x32x16_bf16 v[224:239], v[12:15], v[96:99], v[224:239]
    ds_read_b64_tr_b16 v[12:13], v243 offset:12416
    ds_read_b64_tr_b16 v[14:15], v245 offset:15488
    v_exp_f32 v133, v133
    v_fma_f32 v134, v134, s35, -v248
    v_add_f32 v249, v249, v132
    v_fma_f32 v135, v135, s35, -v248
    v_mfma_f32_32x32x16_bf16 v[224:239], v[4:7], v[100:103], v[224:239]
    s_waitcnt vmcnt(6)
    s_barrier
    ds_read_b64_tr_b16 v[4:5], v243 offset:18560
    ds_read_b64_tr_b16 v[6:7], v245 offset:21632
    v_add_f32 v249, v249, v133
    v_cvt_pk_bf16_f32 v130, v132, v133
    v_exp_f32 v134, v134
L_pv7b:
    s_bitcmp0_b32 s36, 7
    s_cbranch_scc1 L_pv7_inv
    s_waitcnt lgkmcnt(8)
    v_mfma_f32_32x32x16_bf16 v[144:159], v[24:27], v[112:115], v[144:159]
    ds_read_b64_tr_b16 v[24:25], v244 offset:12416
    ds_read_b64_tr_b16 v[26:27], v246 offset:15488
    v_exp_f32 v135, v135
    v_fma_f32 v136, v136, s35, -v248
    v_add_f32 v249, v249, v134
    v_fma_f32 v137, v137, s35, -v248
    v_mfma_f32_32x32x16_bf16 v[144:159], v[28:31], v[116:119], v[144:159]
    ds_read_b64_tr_b16 v[28:29], v244 offset:18560
    ds_read_b64_tr_b16 v[30:31], v246 offset:21632
    v_add_f32 v249, v249, v135
    v_cvt_pk_bf16_f32 v131, v134, v135
    v_exp_f32 v136, v136
    s_waitcnt lgkmcnt(8)
    v_mfma_f32_32x32x16_bf16 v[160:175], v[8:11], v[112:115], v[160:175]
    ds_read_b64_tr_b16 v[8:9], v243 offset:12544
    ds_read_b64_tr_b16 v[10:11], v245 offset:15616
    v_exp_f32 v137, v137
    v_fma_f32 v138, v138, s35, -v248
    v_add_f32 v249, v249, v136
    v_fma_f32 v139, v139, s35, -v248
    s_bitcmp1_b32 s24, 20
    s_cselect_b32 m0, s32, s33
    s_cselect_b32 s14, s83, 0
    buffer_load_dwordx4 v240, s[12:15], s21 offen lds
    v_mfma_f32_32x32x16_bf16 v[160:175], v[0:3], v[116:119], v[160:175]
    ds_read_b64_tr_b16 v[0:1], v243 offset:18688
    ds_read_b64_tr_b16 v[2:3], v245 offset:21760
    v_add_f32 v249, v249, v137
    v_cvt_pk_bf16_f32 v132, v136, v137
    v_exp_f32 v138, v138
    buffer_load_dwordx4 v241, s[12:15], s21 offen offset:1024 lds
    s_waitcnt lgkmcnt(8)
    v_mfma_f32_32x32x16_bf16 v[176:191], v[12:15], v[112:115], v[176:191]
    ds_read_b64_tr_b16 v[12:13], v244 offset:12544
    ds_read_b64_tr_b16 v[14:15], v246 offset:15616
    v_exp_f32 v139, v139
    v_fma_f32 v140, v140, s35, -v248
    v_add_f32 v249, v249, v138
    v_fma_f32 v141, v141, s35, -v248
    s_bitcmp1_b32 s25, 16
    s_cselect_b32 s44, s31, s30
    buffer_load_dwordx4 v242, s[12:15], s21 offen offset:2048 lds
    v_mfma_f32_32x32x16_bf16 v[176:191], v[4:7], v[116:119], v[176:191]
    ds_read_b64_tr_b16 v[4:5], v244 offset:18688
    ds_read_b64_tr_b16 v[6:7], v246 offset:21760
    v_add_f32 v249, v249, v139
    v_cvt_pk_bf16_f32 v133, v138, v139
    v_exp_f32 v140, v140
    s_add_u32 s21, s21, s22
    s_add_u32 s37, s21, s23
    s_min_u32 s21, s21, s37
    s_waitcnt lgkmcnt(8)
    v_mfma_f32_32x32x16_bf16 v[192:207], v[24:27], v[112:115], v[192:207]
    v_add_u32 v243, s44, v243
    v_add_u32 v244, s44, v244
    v_add_u32 v245, s44, v245
    v_add_u32 v246, s44, v246
    ds_read_b64_tr_b16 v[24:25], v243 offset:12288
    ds_read_b64_tr_b16 v[26:27], v245 offset:15360
    s_bitcmp1_b32 s25, 20
    s_cselect_b32 s37, s31, s30
    s_add_u32 s32, s32, s37
    v_mfma_f32_32x32x16_bf16 v[192:207], v[28:31], v[116:119], v[192:207]
    ds_read_b64_tr_b16 v[28:29], v243 offset:18432
    ds_read_b64_tr_b16 v[30:31], v245 offset:21504
    v_exp_f32 v141, v141
    v_fma_f32 v142, v142, s35, -v248
    v_add_f32 v249, v249, v140
    v_fma_f32 v143, v143, s35, -v248
    s_waitcnt lgkmcnt(8)
    v_mfma_f32_32x32x16_bf16 v[208:223], v[8:11], v[112:115], v[208:223]
    ds_read_b64_tr_b16 v[8:9], v244 offset:12288
    ds_read_b64_tr_b16 v[10:11], v246 offset:15360
    v_add_f32 v249, v249, v141
    v_cvt_pk_bf16_f32 v134, v140, v141
    v_exp_f32 v142, v142
    v_mfma_f32_32x32x16_bf16 v[208:223], v[0:3], v[116:119], v[208:223]
    ds_read_b64_tr_b16 v[0:1], v244 offset:18432
    ds_read_b64_tr_b16 v[2:3], v246 offset:21504
    v_exp_f32 v143, v143
    v_add_f32 v249, v249, v142
    v_add_f32 v249, v249, v143
    v_cvt_pk_bf16_f32 v135, v142, v143
    s_waitcnt lgkmcnt(8)
    v_mfma_f32_32x32x16_bf16 v[224:239], v[12:15], v[112:115], v[224:239]
    ds_read_b64_tr_b16 v[12:13], v243 offset:12416
    ds_read_b64_tr_b16 v[14:15], v245 offset:15488
    v_mfma_f32_32x32x16_bf16 v[224:239], v[4:7], v[116:119], v[224:239]
    s_cmp_gt_u32 s20, 6
    s_cbranch_scc1 L_ns18b
    s_waitcnt vmcnt(6)
    s_barrier
L_ns18b:
    ds_read_b64_tr_b16 v[4:5], v243 offset:18560
    ds_read_b64_tr_b16 v[6:7], v245 offset:21632
    s_branch L_pv8
L_code_end:
.section .rodata,"a"
.p2align 6
.amdhsa_kernel standalone__sliding_window_attn__prompt_kernel
  .amdhsa_next_free_vgpr 256
  .amdhsa_next_free_sgpr 102
  .amdhsa_accum_offset 256
  .amdhsa_group_segment_fixed_size 0
  .amdhsa_kernarg_size 56
  .amdhsa_user_sgpr_count 2
  .amdhsa_user_sgpr_kernarg_segment_ptr 1
  .amdhsa_system_sgpr_workgroup_id_x 1
.end_amdhsa_kernel
```
